```python
import torch

def _softmax(x, axis=-1):
    return torch.softmax(x, dim=axis)
def _gelu(x):
    return torch.nn.functional.gelu(x, approximate="tanh")
def _silu(x):
    return torch.nn.functional.silu(x)
def _sigmoid(x):
    return torch.sigmoid(x)
def _layernorm(x, axis=-1, eps=1e-5):
    m = x.mean(dim=axis, keepdim=True)
    v = x.var(dim=axis, keepdim=True, unbiased=False)
    return (x - m) / torch.sqrt(v + eps)
def _scatter_add(tgt, idx, src, axis=0):
    return tgt.clone().index_add_(axis, idx, src)
def _segment_sum(src, seg, n):
    out = torch.zeros((n,) + src.shape[1:], dtype=src.dtype)
    return out.index_add_(0, seg, src)
def _pad(x, pw):
    flat = tuple(v for pair in reversed(pw) for v in pair)
    return torch.nn.functional.pad(x, flat)

kernel_name = 'interleave_layers__ssm_conv_h3__glu_gated_glu__prompt'

def setup_inputs():

    _w = (lambda a: (lambda t: t.to(torch.bfloat16) if t.is_floating_point() else t)(torch.as_tensor(a)))
    def _A_setup():
        B, S, D = 1, 2048, 640
        ks = 4
        return {
            "q": _w((lambda *s: torch.randn(*s, dtype=torch.bfloat16) * 0.05)(B, S, D)),
            "k": _w((lambda *s: torch.randn(*s, dtype=torch.bfloat16) * 0.4)(B, S, D)),
            "v": _w((lambda *s: torch.randn(*s, dtype=torch.bfloat16) * 0.4)(B, S, D)),
            "shift_k": _w((lambda *s: torch.randn(*s, dtype=torch.bfloat16) * 0.4)(D, ks) * 0.5),
            "ssm_k": _w((lambda *s: torch.randn(*s, dtype=torch.bfloat16) * 0.4)(D, S) * (1.0 / S ** 0.5)),
            "ssm_D": _w((lambda *s: torch.randn(*s, dtype=torch.bfloat16) * 0.4)(D)),
        }
    _A_in = _A_setup()

    def _B_setup():
        B, S, D, F = 1, 2048, 640, 1728
        return {
            "x": _w((lambda *s: torch.randn(*s, dtype=torch.bfloat16) * 0.05)(B, S, D)),
            "w_gate": _w((lambda *s: torch.randn(*s, dtype=torch.bfloat16) * 0.05)(D, F)),
            "w_up": _w((lambda *s: torch.randn(*s, dtype=torch.bfloat16) * 0.05)(D, F)),
            "w_down": _w((lambda *s: torch.randn(*s, dtype=torch.bfloat16) * 0.05)(F, D)),
        }
    _B_in = _B_setup()

    return {
        "A_q": _A_in["q"],
        "A_k": _A_in["k"],
        "A_v": _A_in["v"],
        "A_shift_k": _A_in["shift_k"],
        "A_ssm_k": _A_in["ssm_k"],
        "A_ssm_D": _A_in["ssm_D"],
        "B_x": _B_in["x"],
        "B_w_gate": _B_in["w_gate"],
        "B_w_up": _B_in["w_up"],
        "B_w_down": _B_in["w_down"],
    }

def reference(A_q, A_k, A_v, A_shift_k, A_ssm_k, A_ssm_D, B_x, B_w_gate, B_w_up, B_w_down):
    def _A_ref(q, k, v, shift_k, ssm_k, ssm_D):
        B, S, D = q.shape
        ks = shift_k.shape[-1]
        k_pad = _pad(k, ((0, 0), (ks - 1, 0), (0, 0)))
        k_shift = torch.zeros_like(k)
        for t in range(ks):
            k_shift = k_shift + k_pad[:, t:t + S, :] * shift_k[:, ks - 1 - t][None, None, :]
        kv = k_shift * v
        L = 2 * S
        kv_pad = _pad(kv, ((0, 0), (0, S), (0, 0)))
        kf_pad = _pad(ssm_k, ((0, 0), (0, S)))
        kv_f = (lambda x, axes=(-2,-1): torch.fft.rfft2(x.float(), dim=axes))(kv_pad[:, None, :, :], axes=(1, 2))
        kf_f = (lambda x, axes=(-2,-1): torch.fft.rfft2(x.float(), dim=axes))(kf_pad[:, None, :], axes=(1, 2))
        kf_f = (lambda x, *d: x.permute(*d))(kf_f, 1, 2, 0)
        y_f = kv_f * kf_f[None, :, :, :]
        y = (lambda x, s, axes=(-2,-1): torch.fft.irfft2(x, s=s, dim=axes).to(torch.bfloat16))(y_f, (1, L), axes=(1, 2))[:, 0, :S, :]
        y = y + kv * ssm_D[None, None, :]
        return q * y

    def _B_ref(x, w_gate, w_up, w_down):
        g = torch.einsum("bsd,df->bsf", x, w_gate)
        u = torch.einsum("bsd,df->bsf", x, w_up)
        h = _sigmoid(g) * u
        return torch.einsum("bsf,fd->bsd", h, w_down)

    x = A_q
    x = x + _A_ref(_layernorm(x, axis=-1), A_k, A_v, A_shift_k, A_ssm_k, A_ssm_D)
    x = x + _B_ref(_layernorm(x, axis=-1), B_w_gate, B_w_up, B_w_down)
    x = x + _A_ref(_layernorm(x, axis=-1), A_k, A_v, A_shift_k, A_ssm_k, A_ssm_D)
    x = x + _B_ref(_layernorm(x, axis=-1), B_w_gate, B_w_up, B_w_down)
    return x
```

```asm
; @launch kernel=ka_kernel grid=(885,1,1) block=(256,1,1) lds=0
; @launch kernel=k0_kernel grid=(160,1,1) block=(256,1,1) lds=36864
; @launch kernel=k1_kernel grid=(512,1,1) block=(64,1,1) lds=0
; @launch kernel=k2_kernel grid=(216,1,1) block=(256,1,1) lds=32768
; @launch kernel=k3_kernel grid=(320,1,1) block=(256,1,1) lds=65536
; @launch kernel=k4_kernel grid=(512,1,1) block=(64,1,1) lds=0
; @launch kernel=k5_kernel grid=(216,1,1) block=(256,1,1) lds=32768
; @launch kernel=k6_kernel grid=(320,1,1) block=(256,1,1) lds=65536
.amdgcn_target "amdgcn-amd-amdhsa--gfx950"
.text
.globl ka_kernel
.p2align 8
.type ka_kernel,@function
ka_kernel:
    s_cmp_ge_u32 s2, 885
    s_cbranch_scc1 ka_kernel_end
    s_cmp_ge_u32 s2, 480
    s_cbranch_scc1 ka_kernel_pack
    s_cmp_ge_u32 s2, 320
    s_cbranch_scc1 ka_kernel_kp
    s_load_dwordx4 s[4:7], s[0:1], 8
    s_load_dwordx2 s[28:29], s[0:1], 24
    s_load_dwordx2 s[34:35], s[0:1], 96
    s_mul_hi_u32 s40, s2, 429496730
    s_mul_i32 s41, s40, 10
    s_sub_u32 s41, s2, s41
    v_lshrrev_b32 v1, 3, v0
    v_and_b32 v2, 7, v0
    v_lshl_add_u32 v1, s40, 6, v1
    v_lshl_add_u32 v2, s41, 3, v2
    v_mul_u32_u24 v3, 1280, v1
    v_lshl_add_u32 v3, v2, 4, v3
    v_lshlrev_b32 v4, 6, v2
    s_waitcnt lgkmcnt(0)
    s_add_u32 s8, s4, 0
    s_addc_u32 s9, s5, 0
    s_and_b32 s9, s9, 0xffff
    s_mov_b32 s10, 2621440
    s_mov_b32 s11, 0x00020000
    s_add_u32 s12, s6, 0
    s_addc_u32 s13, s7, 0
    s_and_b32 s13, s13, 0xffff
    s_mov_b32 s14, 2621440
    s_mov_b32 s15, 0x00020000
    s_add_u32 s16, s28, 0
    s_addc_u32 s17, s29, 0
    s_and_b32 s17, s17, 0xffff
    s_mov_b32 s18, 5120
    s_mov_b32 s19, 0x00020000
    s_add_u32 s20, s34, 31457280
    s_addc_u32 s21, s35, 0
    s_and_b32 s21, s21, 0xffff
    s_mov_b32 s22, 2621440
    s_mov_b32 s23, 0x00020000
    buffer_load_dwordx4 v[8:11], v4, s[16:19], 0 offen offset:0
    buffer_load_dwordx4 v[12:15], v4, s[16:19], 0 offen offset:16
    buffer_load_dwordx4 v[16:19], v4, s[16:19], 0 offen offset:32
    buffer_load_dwordx4 v[20:23], v4, s[16:19], 0 offen offset:48
    v_subrev_u32 v5, 3840, v3
    buffer_load_dwordx4 v[24:27], v5, s[8:11], 0 offen
    v_add_u32 v5, 1280, v5
    buffer_load_dwordx4 v[28:31], v5, s[8:11], 0 offen
    v_add_u32 v5, 1280, v5
    buffer_load_dwordx4 v[32:35], v5, s[8:11], 0 offen
    v_add_u32 v5, 1280, v5
    buffer_load_dwordx4 v[36:39], v5, s[8:11], 0 offen
    v_add_u32 v5, 1280, v5
    buffer_load_dwordx4 v[40:43], v3, s[12:15], 0 offen
    v_add_u32 v3, 40960, v3
    v_subrev_u32 v5, 3840, v3
    buffer_load_dwordx4 v[44:47], v5, s[8:11], 0 offen
    v_add_u32 v5, 1280, v5
    buffer_load_dwordx4 v[48:51], v5, s[8:11], 0 offen
    v_add_u32 v5, 1280, v5
    buffer_load_dwordx4 v[52:55], v5, s[8:11], 0 offen
    v_add_u32 v5, 1280, v5
    buffer_load_dwordx4 v[56:59], v5, s[8:11], 0 offen
    v_add_u32 v5, 1280, v5
    buffer_load_dwordx4 v[60:63], v3, s[12:15], 0 offen
    v_add_u32 v3, 40960, v3
    v_lshlrev_b32 v6, 15, v2
    v_lshl_add_u32 v6, v1, 3, v6
    s_waitcnt vmcnt(0)
    v_and_b32 v70, 0xffff0000, v9
    v_lshlrev_b32 v71, 16, v24
    v_mul_f32 v72, v70, v71
    v_cvt_pk_bf16_f32 v72, v72, v72
    v_lshlrev_b32 v72, 16, v72
    v_lshlrev_b32 v70, 16, v9
    v_lshlrev_b32 v71, 16, v28
    v_mul_f32 v73, v70, v71
    v_cvt_pk_bf16_f32 v73, v73, v73
    v_lshlrev_b32 v73, 16, v73
    v_add_f32 v72, v72, v73
    v_cvt_pk_bf16_f32 v72, v72, v72
    v_lshlrev_b32 v72, 16, v72
    v_and_b32 v70, 0xffff0000, v8
    v_lshlrev_b32 v71, 16, v32
    v_mul_f32 v73, v70, v71
    v_cvt_pk_bf16_f32 v73, v73, v73
    v_lshlrev_b32 v73, 16, v73
    v_add_f32 v72, v72, v73
    v_cvt_pk_bf16_f32 v72, v72, v72
    v_lshlrev_b32 v72, 16, v72
    v_lshlrev_b32 v70, 16, v8
    v_lshlrev_b32 v71, 16, v36
    v_mul_f32 v73, v70, v71
    v_cvt_pk_bf16_f32 v73, v73, v73
    v_lshlrev_b32 v73, 16, v73
    v_add_f32 v72, v72, v73
    v_cvt_pk_bf16_f32 v72, v72, v72
    v_lshlrev_b32 v72, 16, v72
    v_lshlrev_b32 v71, 16, v40
    v_mul_f32 v64, v72, v71
    v_and_b32 v70, 0xffff0000, v11
    v_and_b32 v71, 0xffff0000, v24
    v_mul_f32 v72, v70, v71
    v_cvt_pk_bf16_f32 v72, v72, v72
    v_lshlrev_b32 v72, 16, v72
    v_lshlrev_b32 v70, 16, v11
    v_and_b32 v71, 0xffff0000, v28
    v_mul_f32 v73, v70, v71
    v_cvt_pk_bf16_f32 v73, v73, v73
    v_lshlrev_b32 v73, 16, v73
    v_add_f32 v72, v72, v73
    v_cvt_pk_bf16_f32 v72, v72, v72
    v_lshlrev_b32 v72, 16, v72
    v_and_b32 v70, 0xffff0000, v10
    v_and_b32 v71, 0xffff0000, v32
    v_mul_f32 v73, v70, v71
    v_cvt_pk_bf16_f32 v73, v73, v73
    v_lshlrev_b32 v73, 16, v73
    v_add_f32 v72, v72, v73
    v_cvt_pk_bf16_f32 v72, v72, v72
    v_lshlrev_b32 v72, 16, v72
    v_lshlrev_b32 v70, 16, v10
    v_and_b32 v71, 0xffff0000, v36
    v_mul_f32 v73, v70, v71
    v_cvt_pk_bf16_f32 v73, v73, v73
    v_lshlrev_b32 v73, 16, v73
    v_add_f32 v72, v72, v73
    v_cvt_pk_bf16_f32 v72, v72, v72
    v_lshlrev_b32 v72, 16, v72
    v_and_b32 v71, 0xffff0000, v40
    v_mul_f32 v65, v72, v71
    v_cvt_pk_bf16_f32 v66, v64, v65
    v_and_b32 v70, 0xffff0000, v13
    v_lshlrev_b32 v71, 16, v25
    v_mul_f32 v72, v70, v71
    v_cvt_pk_bf16_f32 v72, v72, v72
    v_lshlrev_b32 v72, 16, v72
    v_lshlrev_b32 v70, 16, v13
    v_lshlrev_b32 v71, 16, v29
    v_mul_f32 v73, v70, v71
    v_cvt_pk_bf16_f32 v73, v73, v73
    v_lshlrev_b32 v73, 16, v73
    v_add_f32 v72, v72, v73
    v_cvt_pk_bf16_f32 v72, v72, v72
    v_lshlrev_b32 v72, 16, v72
    v_and_b32 v70, 0xffff0000, v12
    v_lshlrev_b32 v71, 16, v33
    v_mul_f32 v73, v70, v71
    v_cvt_pk_bf16_f32 v73, v73, v73
    v_lshlrev_b32 v73, 16, v73
    v_add_f32 v72, v72, v73
    v_cvt_pk_bf16_f32 v72, v72, v72
    v_lshlrev_b32 v72, 16, v72
    v_lshlrev_b32 v70, 16, v12
    v_lshlrev_b32 v71, 16, v37
    v_mul_f32 v73, v70, v71
    v_cvt_pk_bf16_f32 v73, v73, v73
    v_lshlrev_b32 v73, 16, v73
    v_add_f32 v72, v72, v73
    v_cvt_pk_bf16_f32 v72, v72, v72
    v_lshlrev_b32 v72, 16, v72
    v_lshlrev_b32 v71, 16, v41
    v_mul_f32 v64, v72, v71
    v_and_b32 v70, 0xffff0000, v15
    v_and_b32 v71, 0xffff0000, v25
    v_mul_f32 v72, v70, v71
    v_cvt_pk_bf16_f32 v72, v72, v72
    v_lshlrev_b32 v72, 16, v72
    v_lshlrev_b32 v70, 16, v15
    v_and_b32 v71, 0xffff0000, v29
    v_mul_f32 v73, v70, v71
    v_cvt_pk_bf16_f32 v73, v73, v73
    v_lshlrev_b32 v73, 16, v73
    v_add_f32 v72, v72, v73
    v_cvt_pk_bf16_f32 v72, v72, v72
    v_lshlrev_b32 v72, 16, v72
    v_and_b32 v70, 0xffff0000, v14
    v_and_b32 v71, 0xffff0000, v33
    v_mul_f32 v73, v70, v71
    v_cvt_pk_bf16_f32 v73, v73, v73
    v_lshlrev_b32 v73, 16, v73
    v_add_f32 v72, v72, v73
    v_cvt_pk_bf16_f32 v72, v72, v72
    v_lshlrev_b32 v72, 16, v72
    v_lshlrev_b32 v70, 16, v14
    v_and_b32 v71, 0xffff0000, v37
    v_mul_f32 v73, v70, v71
    v_cvt_pk_bf16_f32 v73, v73, v73
    v_lshlrev_b32 v73, 16, v73
    v_add_f32 v72, v72, v73
    v_cvt_pk_bf16_f32 v72, v72, v72
    v_lshlrev_b32 v72, 16, v72
    v_and_b32 v71, 0xffff0000, v41
    v_mul_f32 v65, v72, v71
    v_cvt_pk_bf16_f32 v67, v64, v65
    v_and_b32 v70, 0xffff0000, v17
    v_lshlrev_b32 v71, 16, v26
    v_mul_f32 v72, v70, v71
    v_cvt_pk_bf16_f32 v72, v72, v72
    v_lshlrev_b32 v72, 16, v72
    v_lshlrev_b32 v70, 16, v17
    v_lshlrev_b32 v71, 16, v30
    v_mul_f32 v73, v70, v71
    v_cvt_pk_bf16_f32 v73, v73, v73
    v_lshlrev_b32 v73, 16, v73
    v_add_f32 v72, v72, v73
    v_cvt_pk_bf16_f32 v72, v72, v72
    v_lshlrev_b32 v72, 16, v72
    v_and_b32 v70, 0xffff0000, v16
    v_lshlrev_b32 v71, 16, v34
    v_mul_f32 v73, v70, v71
    v_cvt_pk_bf16_f32 v73, v73, v73
    v_lshlrev_b32 v73, 16, v73
    v_add_f32 v72, v72, v73
    v_cvt_pk_bf16_f32 v72, v72, v72
    v_lshlrev_b32 v72, 16, v72
    v_lshlrev_b32 v70, 16, v16
    v_lshlrev_b32 v71, 16, v38
    v_mul_f32 v73, v70, v71
    v_cvt_pk_bf16_f32 v73, v73, v73
    v_lshlrev_b32 v73, 16, v73
    v_add_f32 v72, v72, v73
    v_cvt_pk_bf16_f32 v72, v72, v72
    v_lshlrev_b32 v72, 16, v72
    v_lshlrev_b32 v71, 16, v42
    v_mul_f32 v64, v72, v71
    v_and_b32 v70, 0xffff0000, v19
    v_and_b32 v71, 0xffff0000, v26
    v_mul_f32 v72, v70, v71
    v_cvt_pk_bf16_f32 v72, v72, v72
    v_lshlrev_b32 v72, 16, v72
    v_lshlrev_b32 v70, 16, v19
    v_and_b32 v71, 0xffff0000, v30
    v_mul_f32 v73, v70, v71
    v_cvt_pk_bf16_f32 v73, v73, v73
    v_lshlrev_b32 v73, 16, v73
    v_add_f32 v72, v72, v73
    v_cvt_pk_bf16_f32 v72, v72, v72
    v_lshlrev_b32 v72, 16, v72
    v_and_b32 v70, 0xffff0000, v18
    v_and_b32 v71, 0xffff0000, v34
    v_mul_f32 v73, v70, v71
    v_cvt_pk_bf16_f32 v73, v73, v73
    v_lshlrev_b32 v73, 16, v73
    v_add_f32 v72, v72, v73
    v_cvt_pk_bf16_f32 v72, v72, v72
    v_lshlrev_b32 v72, 16, v72
    v_lshlrev_b32 v70, 16, v18
    v_and_b32 v71, 0xffff0000, v38
    v_mul_f32 v73, v70, v71
    v_cvt_pk_bf16_f32 v73, v73, v73
    v_lshlrev_b32 v73, 16, v73
    v_add_f32 v72, v72, v73
    v_cvt_pk_bf16_f32 v72, v72, v72
    v_lshlrev_b32 v72, 16, v72
    v_and_b32 v71, 0xffff0000, v42
    v_mul_f32 v65, v72, v71
    v_cvt_pk_bf16_f32 v68, v64, v65
    v_and_b32 v70, 0xffff0000, v21
    v_lshlrev_b32 v71, 16, v27
    v_mul_f32 v72, v70, v71
    v_cvt_pk_bf16_f32 v72, v72, v72
    v_lshlrev_b32 v72, 16, v72
    v_lshlrev_b32 v70, 16, v21
    v_lshlrev_b32 v71, 16, v31
    v_mul_f32 v73, v70, v71
    v_cvt_pk_bf16_f32 v73, v73, v73
    v_lshlrev_b32 v73, 16, v73
    v_add_f32 v72, v72, v73
    v_cvt_pk_bf16_f32 v72, v72, v72
    v_lshlrev_b32 v72, 16, v72
    v_and_b32 v70, 0xffff0000, v20
    v_lshlrev_b32 v71, 16, v35
    v_mul_f32 v73, v70, v71
    v_cvt_pk_bf16_f32 v73, v73, v73
    v_lshlrev_b32 v73, 16, v73
    v_add_f32 v72, v72, v73
    v_cvt_pk_bf16_f32 v72, v72, v72
    v_lshlrev_b32 v72, 16, v72
    v_lshlrev_b32 v70, 16, v20
    v_lshlrev_b32 v71, 16, v39
    v_mul_f32 v73, v70, v71
    v_cvt_pk_bf16_f32 v73, v73, v73
    v_lshlrev_b32 v73, 16, v73
    v_add_f32 v72, v72, v73
    v_cvt_pk_bf16_f32 v72, v72, v72
    v_lshlrev_b32 v72, 16, v72
    v_lshlrev_b32 v71, 16, v43
    v_mul_f32 v64, v72, v71
    v_and_b32 v70, 0xffff0000, v23
    v_and_b32 v71, 0xffff0000, v27
    v_mul_f32 v72, v70, v71
    v_cvt_pk_bf16_f32 v72, v72, v72
    v_lshlrev_b32 v72, 16, v72
    v_lshlrev_b32 v70, 16, v23
    v_and_b32 v71, 0xffff0000, v31
    v_mul_f32 v73, v70, v71
    v_cvt_pk_bf16_f32 v73, v73, v73
    v_lshlrev_b32 v73, 16, v73
    v_add_f32 v72, v72, v73
    v_cvt_pk_bf16_f32 v72, v72, v72
    v_lshlrev_b32 v72, 16, v72
    v_and_b32 v70, 0xffff0000, v22
    v_and_b32 v71, 0xffff0000, v35
    v_mul_f32 v73, v70, v71
    v_cvt_pk_bf16_f32 v73, v73, v73
    v_lshlrev_b32 v73, 16, v73
    v_add_f32 v72, v72, v73
    v_cvt_pk_bf16_f32 v72, v72, v72
    v_lshlrev_b32 v72, 16, v72
    v_lshlrev_b32 v70, 16, v22
    v_and_b32 v71, 0xffff0000, v39
    v_mul_f32 v73, v70, v71
    v_cvt_pk_bf16_f32 v73, v73, v73
    v_lshlrev_b32 v73, 16, v73
    v_add_f32 v72, v72, v73
    v_cvt_pk_bf16_f32 v72, v72, v72
    v_lshlrev_b32 v72, 16, v72
    v_and_b32 v71, 0xffff0000, v43
    v_mul_f32 v65, v72, v71
    v_cvt_pk_bf16_f32 v69, v64, v65
    buffer_store_dwordx2 v[66:67], v6, s[20:23], 0 offen offset:0
    v_add_u32 v7, 16384, v6
    buffer_store_dwordx2 v[68:69], v7, s[20:23], 0 offen offset:0
    s_nop 1
    v_and_b32 v70, 0xffff0000, v9
    v_lshlrev_b32 v71, 16, v44
    v_mul_f32 v72, v70, v71
    v_cvt_pk_bf16_f32 v72, v72, v72
    v_lshlrev_b32 v72, 16, v72
    v_lshlrev_b32 v70, 16, v9
    v_lshlrev_b32 v71, 16, v48
    v_mul_f32 v73, v70, v71
    v_cvt_pk_bf16_f32 v73, v73, v73
    v_lshlrev_b32 v73, 16, v73
    v_add_f32 v72, v72, v73
    v_cvt_pk_bf16_f32 v72, v72, v72
    v_lshlrev_b32 v72, 16, v72
    v_and_b32 v70, 0xffff0000, v8
    v_lshlrev_b32 v71, 16, v52
    v_mul_f32 v73, v70, v71
    v_cvt_pk_bf16_f32 v73, v73, v73
    v_lshlrev_b32 v73, 16, v73
    v_add_f32 v72, v72, v73
    v_cvt_pk_bf16_f32 v72, v72, v72
    v_lshlrev_b32 v72, 16, v72
    v_lshlrev_b32 v70, 16, v8
    v_lshlrev_b32 v71, 16, v56
    v_mul_f32 v73, v70, v71
    v_cvt_pk_bf16_f32 v73, v73, v73
    v_lshlrev_b32 v73, 16, v73
    v_add_f32 v72, v72, v73
    v_cvt_pk_bf16_f32 v72, v72, v72
    v_lshlrev_b32 v72, 16, v72
    v_lshlrev_b32 v71, 16, v60
    v_mul_f32 v64, v72, v71
    v_and_b32 v70, 0xffff0000, v11
    v_and_b32 v71, 0xffff0000, v44
    v_mul_f32 v72, v70, v71
    v_cvt_pk_bf16_f32 v72, v72, v72
    v_lshlrev_b32 v72, 16, v72
    v_lshlrev_b32 v70, 16, v11
    v_and_b32 v71, 0xffff0000, v48
    v_mul_f32 v73, v70, v71
    v_cvt_pk_bf16_f32 v73, v73, v73
    v_lshlrev_b32 v73, 16, v73
    v_add_f32 v72, v72, v73
    v_cvt_pk_bf16_f32 v72, v72, v72
    v_lshlrev_b32 v72, 16, v72
    v_and_b32 v70, 0xffff0000, v10
    v_and_b32 v71, 0xffff0000, v52
    v_mul_f32 v73, v70, v71
    v_cvt_pk_bf16_f32 v73, v73, v73
    v_lshlrev_b32 v73, 16, v73
    v_add_f32 v72, v72, v73
    v_cvt_pk_bf16_f32 v72, v72, v72
    v_lshlrev_b32 v72, 16, v72
    v_lshlrev_b32 v70, 16, v10
    v_and_b32 v71, 0xffff0000, v56
    v_mul_f32 v73, v70, v71
    v_cvt_pk_bf16_f32 v73, v73, v73
    v_lshlrev_b32 v73, 16, v73
    v_add_f32 v72, v72, v73
    v_cvt_pk_bf16_f32 v72, v72, v72
    v_lshlrev_b32 v72, 16, v72
    v_and_b32 v71, 0xffff0000, v60
    v_mul_f32 v65, v72, v71
    v_cvt_pk_bf16_f32 v66, v64, v65
    v_and_b32 v70, 0xffff0000, v13
    v_lshlrev_b32 v71, 16, v45
    v_mul_f32 v72, v70, v71
    v_cvt_pk_bf16_f32 v72, v72, v72
    v_lshlrev_b32 v72, 16, v72
    v_lshlrev_b32 v70, 16, v13
    v_lshlrev_b32 v71, 16, v49
    v_mul_f32 v73, v70, v71
    v_cvt_pk_bf16_f32 v73, v73, v73
    v_lshlrev_b32 v73, 16, v73
    v_add_f32 v72, v72, v73
    v_cvt_pk_bf16_f32 v72, v72, v72
    v_lshlrev_b32 v72, 16, v72
    v_and_b32 v70, 0xffff0000, v12
    v_lshlrev_b32 v71, 16, v53
    v_mul_f32 v73, v70, v71
    v_cvt_pk_bf16_f32 v73, v73, v73
    v_lshlrev_b32 v73, 16, v73
    v_add_f32 v72, v72, v73
    v_cvt_pk_bf16_f32 v72, v72, v72
    v_lshlrev_b32 v72, 16, v72
    v_lshlrev_b32 v70, 16, v12
    v_lshlrev_b32 v71, 16, v57
    v_mul_f32 v73, v70, v71
    v_cvt_pk_bf16_f32 v73, v73, v73
    v_lshlrev_b32 v73, 16, v73
    v_add_f32 v72, v72, v73
    v_cvt_pk_bf16_f32 v72, v72, v72
    v_lshlrev_b32 v72, 16, v72
    v_lshlrev_b32 v71, 16, v61
    v_mul_f32 v64, v72, v71
    v_and_b32 v70, 0xffff0000, v15
    v_and_b32 v71, 0xffff0000, v45
    v_mul_f32 v72, v70, v71
    v_cvt_pk_bf16_f32 v72, v72, v72
    v_lshlrev_b32 v72, 16, v72
    v_lshlrev_b32 v70, 16, v15
    v_and_b32 v71, 0xffff0000, v49
    v_mul_f32 v73, v70, v71
    v_cvt_pk_bf16_f32 v73, v73, v73
    v_lshlrev_b32 v73, 16, v73
    v_add_f32 v72, v72, v73
    v_cvt_pk_bf16_f32 v72, v72, v72
    v_lshlrev_b32 v72, 16, v72
    v_and_b32 v70, 0xffff0000, v14
    v_and_b32 v71, 0xffff0000, v53
    v_mul_f32 v73, v70, v71
    v_cvt_pk_bf16_f32 v73, v73, v73
    v_lshlrev_b32 v73, 16, v73
    v_add_f32 v72, v72, v73
    v_cvt_pk_bf16_f32 v72, v72, v72
    v_lshlrev_b32 v72, 16, v72
    v_lshlrev_b32 v70, 16, v14
    v_and_b32 v71, 0xffff0000, v57
    v_mul_f32 v73, v70, v71
    v_cvt_pk_bf16_f32 v73, v73, v73
    v_lshlrev_b32 v73, 16, v73
    v_add_f32 v72, v72, v73
    v_cvt_pk_bf16_f32 v72, v72, v72
    v_lshlrev_b32 v72, 16, v72
    v_and_b32 v71, 0xffff0000, v61
    v_mul_f32 v65, v72, v71
    v_cvt_pk_bf16_f32 v67, v64, v65
    v_and_b32 v70, 0xffff0000, v17
    v_lshlrev_b32 v71, 16, v46
    v_mul_f32 v72, v70, v71
    v_cvt_pk_bf16_f32 v72, v72, v72
    v_lshlrev_b32 v72, 16, v72
    v_lshlrev_b32 v70, 16, v17
    v_lshlrev_b32 v71, 16, v50
    v_mul_f32 v73, v70, v71
    v_cvt_pk_bf16_f32 v73, v73, v73
    v_lshlrev_b32 v73, 16, v73
    v_add_f32 v72, v72, v73
    v_cvt_pk_bf16_f32 v72, v72, v72
    v_lshlrev_b32 v72, 16, v72
    v_and_b32 v70, 0xffff0000, v16
    v_lshlrev_b32 v71, 16, v54
    v_mul_f32 v73, v70, v71
    v_cvt_pk_bf16_f32 v73, v73, v73
    v_lshlrev_b32 v73, 16, v73
    v_add_f32 v72, v72, v73
    v_cvt_pk_bf16_f32 v72, v72, v72
    v_lshlrev_b32 v72, 16, v72
    v_lshlrev_b32 v70, 16, v16
    v_lshlrev_b32 v71, 16, v58
    v_mul_f32 v73, v70, v71
    v_cvt_pk_bf16_f32 v73, v73, v73
    v_lshlrev_b32 v73, 16, v73
    v_add_f32 v72, v72, v73
    v_cvt_pk_bf16_f32 v72, v72, v72
    v_lshlrev_b32 v72, 16, v72
    v_lshlrev_b32 v71, 16, v62
    v_mul_f32 v64, v72, v71
    v_and_b32 v70, 0xffff0000, v19
    v_and_b32 v71, 0xffff0000, v46
    v_mul_f32 v72, v70, v71
    v_cvt_pk_bf16_f32 v72, v72, v72
    v_lshlrev_b32 v72, 16, v72
    v_lshlrev_b32 v70, 16, v19
    v_and_b32 v71, 0xffff0000, v50
    v_mul_f32 v73, v70, v71
    v_cvt_pk_bf16_f32 v73, v73, v73
    v_lshlrev_b32 v73, 16, v73
    v_add_f32 v72, v72, v73
    v_cvt_pk_bf16_f32 v72, v72, v72
    v_lshlrev_b32 v72, 16, v72
    v_and_b32 v70, 0xffff0000, v18
    v_and_b32 v71, 0xffff0000, v54
    v_mul_f32 v73, v70, v71
    v_cvt_pk_bf16_f32 v73, v73, v73
    v_lshlrev_b32 v73, 16, v73
    v_add_f32 v72, v72, v73
    v_cvt_pk_bf16_f32 v72, v72, v72
    v_lshlrev_b32 v72, 16, v72
    v_lshlrev_b32 v70, 16, v18
    v_and_b32 v71, 0xffff0000, v58
    v_mul_f32 v73, v70, v71
    v_cvt_pk_bf16_f32 v73, v73, v73
    v_lshlrev_b32 v73, 16, v73
    v_add_f32 v72, v72, v73
    v_cvt_pk_bf16_f32 v72, v72, v72
    v_lshlrev_b32 v72, 16, v72
    v_and_b32 v71, 0xffff0000, v62
    v_mul_f32 v65, v72, v71
    v_cvt_pk_bf16_f32 v68, v64, v65
    v_and_b32 v70, 0xffff0000, v21
    v_lshlrev_b32 v71, 16, v47
    v_mul_f32 v72, v70, v71
    v_cvt_pk_bf16_f32 v72, v72, v72
    v_lshlrev_b32 v72, 16, v72
    v_lshlrev_b32 v70, 16, v21
    v_lshlrev_b32 v71, 16, v51
    v_mul_f32 v73, v70, v71
    v_cvt_pk_bf16_f32 v73, v73, v73
    v_lshlrev_b32 v73, 16, v73
    v_add_f32 v72, v72, v73
    v_cvt_pk_bf16_f32 v72, v72, v72
    v_lshlrev_b32 v72, 16, v72
    v_and_b32 v70, 0xffff0000, v20
    v_lshlrev_b32 v71, 16, v55
    v_mul_f32 v73, v70, v71
    v_cvt_pk_bf16_f32 v73, v73, v73
    v_lshlrev_b32 v73, 16, v73
    v_add_f32 v72, v72, v73
    v_cvt_pk_bf16_f32 v72, v72, v72
    v_lshlrev_b32 v72, 16, v72
    v_lshlrev_b32 v70, 16, v20
    v_lshlrev_b32 v71, 16, v59
    v_mul_f32 v73, v70, v71
    v_cvt_pk_bf16_f32 v73, v73, v73
    v_lshlrev_b32 v73, 16, v73
    v_add_f32 v72, v72, v73
    v_cvt_pk_bf16_f32 v72, v72, v72
    v_lshlrev_b32 v72, 16, v72
    v_lshlrev_b32 v71, 16, v63
    v_mul_f32 v64, v72, v71
    v_and_b32 v70, 0xffff0000, v23
    v_and_b32 v71, 0xffff0000, v47
    v_mul_f32 v72, v70, v71
    v_cvt_pk_bf16_f32 v72, v72, v72
    v_lshlrev_b32 v72, 16, v72
    v_lshlrev_b32 v70, 16, v23
    v_and_b32 v71, 0xffff0000, v51
    v_mul_f32 v73, v70, v71
    v_cvt_pk_bf16_f32 v73, v73, v73
    v_lshlrev_b32 v73, 16, v73
    v_add_f32 v72, v72, v73
    v_cvt_pk_bf16_f32 v72, v72, v72
    v_lshlrev_b32 v72, 16, v72
    v_and_b32 v70, 0xffff0000, v22
    v_and_b32 v71, 0xffff0000, v55
    v_mul_f32 v73, v70, v71
    v_cvt_pk_bf16_f32 v73, v73, v73
    v_lshlrev_b32 v73, 16, v73
    v_add_f32 v72, v72, v73
    v_cvt_pk_bf16_f32 v72, v72, v72
    v_lshlrev_b32 v72, 16, v72
    v_lshlrev_b32 v70, 16, v22
    v_and_b32 v71, 0xffff0000, v59
    v_mul_f32 v73, v70, v71
    v_cvt_pk_bf16_f32 v73, v73, v73
    v_lshlrev_b32 v73, 16, v73
    v_add_f32 v72, v72, v73
    v_cvt_pk_bf16_f32 v72, v72, v72
    v_lshlrev_b32 v72, 16, v72
    v_and_b32 v71, 0xffff0000, v63
    v_mul_f32 v65, v72, v71
    v_cvt_pk_bf16_f32 v69, v64, v65
    buffer_store_dwordx2 v[66:67], v6, s[20:23], 0 offen offset:256
    v_add_u32 v7, 16384, v6
    buffer_store_dwordx2 v[68:69], v7, s[20:23], 0 offen offset:256
    s_nop 1
    s_endpgm
ka_kernel_kp:
    s_load_dwordx2 s[4:5], s[0:1], 32
    s_load_dwordx2 s[34:35], s[0:1], 96
    s_sub_u32 s40, s2, 320
    v_lshrrev_b32 v1, 6, v0
    v_and_b32 v2, 63, v0
    v_lshl_add_u32 v1, s40, 2, v1
    v_lshlrev_b32 v3, 12, v1
    v_lshl_add_u32 v3, v2, 4, v3
    v_mul_u32_u24 v4, 9280, v1
    v_lshl_add_u32 v4, v2, 4, v4
    s_waitcnt lgkmcnt(0)
    s_add_u32 s8, s4, 0
    s_addc_u32 s9, s5, 0
    s_and_b32 s9, s9, 0xffff
    s_mov_b32 s10, 2621440
    s_mov_b32 s11, 0x00020000
    s_add_u32 s12, s34, 34603008
    s_addc_u32 s13, s35, 0
    s_and_b32 s13, s13, 0xffff
    s_mov_b32 s14, 5939200
    s_mov_b32 s15, 0x00020000
    buffer_load_dwordx4 v[8:11], v3, s[8:11], 0 offen offset:0
    buffer_load_dwordx4 v[12:15], v3, s[8:11], 0 offen offset:1024
    buffer_load_dwordx4 v[16:19], v3, s[8:11], 0 offen offset:2048
    buffer_load_dwordx4 v[20:23], v3, s[8:11], 0 offen offset:3072
    v_mov_b32 v24, 0
    v_mov_b32 v25, 0
    v_mov_b32 v26, 0
    v_mov_b32 v27, 0
    v_cmp_gt_u32 vcc, 33, v2
    s_and_saveexec_b64 s[20:21], vcc
    v_add_u32 v5, 4096, v4
    buffer_store_dwordx4 v[24:27], v5, s[12:15], 0 offen offset:16
    v_add_u32 v5, 4640, v5
    buffer_store_dwordx4 v[24:27], v5, s[12:15], 0 offen offset:16
    v_cmp_gt_u32 vcc, 2, v2
    s_and_b64 exec, exec, vcc
    buffer_store_dwordx4 v[24:27], v4, s[12:15], 0 offen
    v_add_u32 v5, 4640, v4
    buffer_store_dwordx4 v[24:27], v5, s[12:15], 0 offen
    s_mov_b64 exec, s[20:21]
    s_waitcnt vmcnt(0)
    v_add_u32 v5, 4640, v4
    buffer_store_dwordx4 v[8:11], v4, s[12:15], 0 offen offset:32
    buffer_store_dwordx4 v[12:15], v4, s[12:15], 0 offen offset:1056
    buffer_store_dwordx4 v[16:19], v4, s[12:15], 0 offen offset:2080
    buffer_store_dwordx4 v[20:23], v4, s[12:15], 0 offen offset:3104
    buffer_store_dwordx4 v[8:11], v5, s[12:15], 0 offen offset:30
    buffer_store_dwordx4 v[12:15], v5, s[12:15], 0 offen offset:1054
    buffer_store_dwordx4 v[16:19], v5, s[12:15], 0 offen offset:2078
    buffer_store_dwordx4 v[20:23], v5, s[12:15], 0 offen offset:3102
    s_endpgm
ka_kernel_pack:
    s_load_dwordx4 s[4:7], s[0:1], 56
    s_load_dwordx2 s[28:29], s[0:1], 72
    s_load_dwordx2 s[34:35], s[0:1], 96
    v_lshrrev_b32 v4, 6, v0
    s_nop 1
    v_readfirstlane_b32 s3, v4
    s_sub_u32 s40, s2, 480
    s_lshl_b32 s40, s40, 2
    s_add_u32 s40, s40, s3
    s_lshl_b32 s40, s40, 2
    v_and_b32 v5, 31, v0
    v_bfe_u32 v6, v0, 5, 1
    s_waitcnt lgkmcnt(0)
    s_add_u32 s16, s34, 0
    s_addc_u32 s17, s35, 0
    s_and_b32 s17, s17, 0xffff
    s_mov_b32 s18, 6956032
    s_mov_b32 s19, 0x00020000
    s_lshl_b32 s47, s40, 10
    s_cmp_ge_u32 s40, 4320
    s_cbranch_scc1 ka_kernel_pd
    s_mul_hi_u32 s41, s40, 107374183
    s_mul_i32 s42, s41, 40
    s_sub_u32 s42, s40, s42
    s_mul_i32 s47, s41, 42240
    s_lshl_b32 s49, s42, 10
    s_add_u32 s47, s47, s49
    s_and_b32 s43, s41, 1
    s_cmp_eq_u32 s43, 0
    s_cselect_b32 s44, s4, s6
    s_cselect_b32 s45, s5, s7
    s_add_u32 s8, s44, 0
    s_addc_u32 s9, s45, 0
    s_and_b32 s9, s9, 0xffff
    s_mov_b32 s10, 2211840
    s_mov_b32 s11, 0x00020000
    s_lshr_b32 s43, s41, 1
    s_lshl_b32 s43, s43, 5
    s_movk_i32 s46, 3456
    s_branch ka_kernel_pgo
ka_kernel_pd:
    s_sub_u32 s40, s40, 4320
    s_mul_hi_u32 s41, s40, 39768216
    s_mul_i32 s42, s41, 108
    s_sub_u32 s42, s40, s42
    s_add_u32 s8, s28, 0
    s_addc_u32 s9, s29, 0
    s_and_b32 s9, s9, 0xffff
    s_mov_b32 s10, 2211840
    s_mov_b32 s11, 0x00020000
    s_lshl_b32 s43, s41, 5
    s_movk_i32 s46, 1280
    s_mul_i32 s47, s41, 111872
    s_lshl_b32 s49, s42, 10
    s_add_u32 s47, s47, s49
    s_add_u32 s47, s47, 4718592
ka_kernel_pgo:
    s_lshl_b32 s42, s42, 4
    v_lshl_add_u32 v6, v6, 3, s42
    v_mul_lo_u32 v6, v6, s46
    v_add_u32 v5, s43, v5
    v_lshl_add_u32 v6, v5, 1, v6
    s_lshl_b32 s48, s46, 3
    buffer_load_ushort v10, v6, s[8:11], 0 offen
    v_add_u32 v6, s46, v6
    buffer_load_ushort v30, v6, s[8:11], 0 offen
    v_add_u32 v6, s46, v6
    buffer_load_ushort v11, v6, s[8:11], 0 offen
    v_add_u32 v6, s46, v6
    buffer_load_ushort v31, v6, s[8:11], 0 offen
    v_add_u32 v6, s46, v6
    buffer_load_ushort v12, v6, s[8:11], 0 offen
    v_add_u32 v6, s46, v6
    buffer_load_ushort v32, v6, s[8:11], 0 offen
    v_add_u32 v6, s46, v6
    buffer_load_ushort v13, v6, s[8:11], 0 offen
    v_add_u32 v6, s46, v6
    buffer_load_ushort v33, v6, s[8:11], 0 offen
    v_add_u32 v6, s46, v6
    v_add_u32 v6, s48, v6
    buffer_load_ushort v14, v6, s[8:11], 0 offen
    v_add_u32 v6, s46, v6
    buffer_load_ushort v34, v6, s[8:11], 0 offen
    v_add_u32 v6, s46, v6
    buffer_load_ushort v15, v6, s[8:11], 0 offen
    v_add_u32 v6, s46, v6
    buffer_load_ushort v35, v6, s[8:11], 0 offen
    v_add_u32 v6, s46, v6
    buffer_load_ushort v16, v6, s[8:11], 0 offen
    v_add_u32 v6, s46, v6
    buffer_load_ushort v36, v6, s[8:11], 0 offen
    v_add_u32 v6, s46, v6
    buffer_load_ushort v17, v6, s[8:11], 0 offen
    v_add_u32 v6, s46, v6
    buffer_load_ushort v37, v6, s[8:11], 0 offen
    v_add_u32 v6, s46, v6
    v_add_u32 v6, s48, v6
    buffer_load_ushort v18, v6, s[8:11], 0 offen
    v_add_u32 v6, s46, v6
    buffer_load_ushort v38, v6, s[8:11], 0 offen
    v_add_u32 v6, s46, v6
    buffer_load_ushort v19, v6, s[8:11], 0 offen
    v_add_u32 v6, s46, v6
    buffer_load_ushort v39, v6, s[8:11], 0 offen
    v_add_u32 v6, s46, v6
    buffer_load_ushort v20, v6, s[8:11], 0 offen
    v_add_u32 v6, s46, v6
    buffer_load_ushort v40, v6, s[8:11], 0 offen
    v_add_u32 v6, s46, v6
    buffer_load_ushort v21, v6, s[8:11], 0 offen
    v_add_u32 v6, s46, v6
    buffer_load_ushort v41, v6, s[8:11], 0 offen
    v_add_u32 v6, s46, v6
    v_add_u32 v6, s48, v6
    buffer_load_ushort v22, v6, s[8:11], 0 offen
    v_add_u32 v6, s46, v6
    buffer_load_ushort v42, v6, s[8:11], 0 offen
    v_add_u32 v6, s46, v6
    buffer_load_ushort v23, v6, s[8:11], 0 offen
    v_add_u32 v6, s46, v6
    buffer_load_ushort v43, v6, s[8:11], 0 offen
    v_add_u32 v6, s46, v6
    buffer_load_ushort v24, v6, s[8:11], 0 offen
    v_add_u32 v6, s46, v6
    buffer_load_ushort v44, v6, s[8:11], 0 offen
    v_add_u32 v6, s46, v6
    buffer_load_ushort v25, v6, s[8:11], 0 offen
    v_add_u32 v6, s46, v6
    buffer_load_ushort v45, v6, s[8:11], 0 offen
    v_add_u32 v6, s46, v6
    v_add_u32 v6, s48, v6
    v_and_b32 v7, 63, v0
    v_lshlrev_b32 v7, 4, v7
    s_waitcnt vmcnt(0)
    v_lshl_or_b32 v10, v30, 16, v10
    v_lshl_or_b32 v11, v31, 16, v11
    v_lshl_or_b32 v12, v32, 16, v12
    v_lshl_or_b32 v13, v33, 16, v13
    v_lshl_or_b32 v14, v34, 16, v14
    v_lshl_or_b32 v15, v35, 16, v15
    v_lshl_or_b32 v16, v36, 16, v16
    v_lshl_or_b32 v17, v37, 16, v17
    v_lshl_or_b32 v18, v38, 16, v18
    v_lshl_or_b32 v19, v39, 16, v19
    v_lshl_or_b32 v20, v40, 16, v20
    v_lshl_or_b32 v21, v41, 16, v21
    v_lshl_or_b32 v22, v42, 16, v22
    v_lshl_or_b32 v23, v43, 16, v23
    v_lshl_or_b32 v24, v44, 16, v24
    v_lshl_or_b32 v25, v45, 16, v25
    buffer_store_dwordx4 v[10:13], v7, s[16:19], s47 offen offset:0
    buffer_store_dwordx4 v[14:17], v7, s[16:19], s47 offen offset:1024
    buffer_store_dwordx4 v[18:21], v7, s[16:19], s47 offen offset:2048
    buffer_store_dwordx4 v[22:25], v7, s[16:19], s47 offen offset:3072
ka_kernel_end:
    s_endpgm
.globl k0_kernel
.p2align 8
.type k0_kernel,@function
k0_kernel:
    s_cmp_ge_u32 s2, 160
    s_cbranch_scc1 k0_kernel_end
    s_load_dwordx2 s[32:33], s[0:1], 40
    s_load_dwordx2 s[34:35], s[0:1], 96
    v_lshlrev_b32 v1, 4, v0
    v_mov_b32 v4, 0
    v_mov_b32 v5, 0
    v_mov_b32 v6, 0
    v_mov_b32 v7, 0
    ds_write_b128 v1, v[4:7] offset:0
    ds_write_b128 v1, v[4:7] offset:4096
    ds_write_b128 v1, v[4:7] offset:8192
    ds_write_b128 v1, v[4:7] offset:12288
    ds_write_b128 v1, v[4:7] offset:16384
    s_waitcnt lgkmcnt(0)
    s_add_u32 s8, s34, 31457280
    s_addc_u32 s9, s35, 0
    s_and_b32 s9, s9, 0xffff
    s_mov_b32 s10, 2621440
    s_mov_b32 s11, 0x00020000
    s_add_u32 s20, s34, 34603008
    s_addc_u32 s21, s35, 0
    s_and_b32 s21, s21, 0xffff
    s_mov_b32 s22, 5939200
    s_mov_b32 s23, 0x00020000
    s_add_u32 s24, s32, 0
    s_addc_u32 s25, s33, 0
    s_and_b32 s25, s25, 0xffff
    s_mov_b32 s26, 1280
    s_mov_b32 s27, 0x00020000
    s_add_u32 s36, s34, 7340032
    s_addc_u32 s37, s35, 0
    s_and_b32 s37, s37, 0xffff
    s_mov_b32 s38, 2621440
    s_mov_b32 s39, 0x00020000
    s_lshl_b32 s3, s2, 14
    v_add_u32 v2, s3, v1
    buffer_load_dwordx4 v[8:11], v2, s[8:11], 0 offen
    v_add_u32 v2, 4096, v2
    buffer_load_dwordx4 v[12:15], v2, s[8:11], 0 offen
    v_add_u32 v2, 4096, v2
    buffer_load_dwordx4 v[16:19], v2, s[8:11], 0 offen
    v_add_u32 v2, 4096, v2
    buffer_load_dwordx4 v[20:23], v2, s[8:11], 0 offen
    v_add_u32 v2, 4096, v2
    v_lshrrev_b32 v4, 6, v0
    v_and_b32 v5, 63, v0
    v_mul_u32_u24 v7, 5120, v4
    v_lshlrev_b32 v9, 2, v0
    v_sub_u32 v3, 1054, v9
    s_barrier
    s_waitcnt vmcnt(0)
    ds_write_b16 v3, v8 offset:3074
    ds_write_b16_d16_hi v3, v8 offset:8194
    ds_write_b16 v3, v9 offset:13314
    ds_write_b16_d16_hi v3, v9 offset:18434
    ds_write_b16 v3, v10 offset:3072
    ds_write_b16_d16_hi v3, v10 offset:8192
    ds_write_b16 v3, v11 offset:13312
    ds_write_b16_d16_hi v3, v11 offset:18432
    ds_write_b16 v3, v12 offset:2050
    ds_write_b16_d16_hi v3, v12 offset:7170
    ds_write_b16 v3, v13 offset:12290
    ds_write_b16_d16_hi v3, v13 offset:17410
    ds_write_b16 v3, v14 offset:2048
    ds_write_b16_d16_hi v3, v14 offset:7168
    ds_write_b16 v3, v15 offset:12288
    ds_write_b16_d16_hi v3, v15 offset:17408
    ds_write_b16 v3, v16 offset:1026
    ds_write_b16_d16_hi v3, v16 offset:6146
    ds_write_b16 v3, v17 offset:11266
    ds_write_b16_d16_hi v3, v17 offset:16386
    ds_write_b16 v3, v18 offset:1024
    ds_write_b16_d16_hi v3, v18 offset:6144
    ds_write_b16 v3, v19 offset:11264
    ds_write_b16_d16_hi v3, v19 offset:16384
    ds_write_b16 v3, v20 offset:2
    ds_write_b16_d16_hi v3, v20 offset:5122
    ds_write_b16 v3, v21 offset:10242
    ds_write_b16_d16_hi v3, v21 offset:15362
    ds_write_b16 v3, v22 offset:0
    ds_write_b16_d16_hi v3, v22 offset:5120
    ds_write_b16 v3, v23 offset:10240
    ds_write_b16_d16_hi v3, v23 offset:15360
    s_waitcnt lgkmcnt(0)
    s_barrier
    v_and_b32 v10, 15, v5
    v_lshrrev_b32 v11, 4, v5
    v_lshl_add_u32 v6, s2, 2, v4
    v_mul_u32_u24 v12, 9280, v6
    v_and_b32 v14, 1, v10
    v_mul_u32_u24 v14, 4638, v14
    v_add_u32 v12, v12, v14
    v_lshl_add_u32 v12, v10, 1, v12
    v_lshl_add_u32 v12, v11, 4, v12
    v_lshlrev_b32 v13, 5, v10
    v_lshlrev_b32 v14, 4, v11
    v_sub_u32 v13, v14, v13
    v_add_u32 v13, v7, v13
    v_mov_b32 v16, 0
    v_mov_b32 v17, 0
    v_mov_b32 v18, 0
    v_mov_b32 v19, 0
    v_mov_b32 v20, 0
    v_mov_b32 v21, 0
    v_mov_b32 v22, 0
    v_mov_b32 v23, 0
    v_mov_b32 v24, 0
    v_mov_b32 v25, 0
    v_mov_b32 v26, 0
    v_mov_b32 v27, 0
    v_mov_b32 v28, 0
    v_mov_b32 v29, 0
    v_mov_b32 v30, 0
    v_mov_b32 v31, 0
    v_mov_b32 v32, 0
    v_mov_b32 v33, 0
    v_mov_b32 v34, 0
    v_mov_b32 v35, 0
    v_mov_b32 v36, 0
    v_mov_b32 v37, 0
    v_mov_b32 v38, 0
    v_mov_b32 v39, 0
    v_mov_b32 v40, 0
    v_mov_b32 v41, 0
    v_mov_b32 v42, 0
    v_mov_b32 v43, 0
    v_mov_b32 v44, 0
    v_mov_b32 v45, 0
    v_mov_b32 v46, 0
    v_mov_b32 v47, 0
    s_mov_b32 s41, 0
    buffer_load_dwordx4 v[84:87], v12, s[20:23], 0 offen offset:0
    buffer_load_dwordx4 v[88:91], v12, s[20:23], 0 offen offset:512
    buffer_load_dwordx4 v[92:95], v12, s[20:23], 0 offen offset:1024
    buffer_load_dwordx4 v[96:99], v12, s[20:23], 0 offen offset:1536
    buffer_load_dwordx4 v[100:103], v12, s[20:23], 0 offen offset:2048
    buffer_load_dwordx4 v[104:107], v12, s[20:23], 0 offen offset:2560
    buffer_load_dwordx4 v[108:111], v12, s[20:23], 0 offen offset:3072
    buffer_load_dwordx4 v[112:115], v12, s[20:23], 0 offen offset:3584
    v_add_u32 v15, 4096, v12
    buffer_load_dwordx4 v[116:119], v15, s[20:23], 0 offen
    v_add_u32 v12, 64, v12
k0_kernel_rl:
    ds_read_b128 v[48:51], v13 offset:512
    ds_read_b128 v[52:55], v13 offset:1024
    ds_read_b128 v[56:59], v13 offset:1536
    ds_read_b128 v[60:63], v13 offset:2048
    ds_read_b128 v[64:67], v13 offset:2560
    ds_read_b128 v[68:71], v13 offset:3072
    ds_read_b128 v[72:75], v13 offset:3584
    ds_read_b128 v[76:79], v13 offset:4096
    ds_read_b128 v[80:83], v13 offset:4608
    buffer_load_dwordx4 v[120:123], v12, s[20:23], 0 offen offset:0
    buffer_load_dwordx4 v[124:127], v12, s[20:23], 0 offen offset:512
    buffer_load_dwordx4 v[128:131], v12, s[20:23], 0 offen offset:1024
    buffer_load_dwordx4 v[132:135], v12, s[20:23], 0 offen offset:1536
    buffer_load_dwordx4 v[136:139], v12, s[20:23], 0 offen offset:2048
    buffer_load_dwordx4 v[140:143], v12, s[20:23], 0 offen offset:2560
    buffer_load_dwordx4 v[144:147], v12, s[20:23], 0 offen offset:3072
    buffer_load_dwordx4 v[148:151], v12, s[20:23], 0 offen offset:3584
    v_add_u32 v15, 4096, v12
    buffer_load_dwordx4 v[152:155], v15, s[20:23], 0 offen
    v_add_u32 v12, 64, v12
    s_waitcnt lgkmcnt(0)
    s_waitcnt vmcnt(17)
    v_mfma_f32_16x16x32_bf16 v[16:19], v[84:87], v[76:79], v[16:19]
    v_mfma_f32_16x16x32_bf16 v[20:23], v[84:87], v[72:75], v[20:23]
    v_mfma_f32_16x16x32_bf16 v[24:27], v[84:87], v[68:71], v[24:27]
    v_mfma_f32_16x16x32_bf16 v[28:31], v[84:87], v[64:67], v[28:31]
    v_mfma_f32_16x16x32_bf16 v[32:35], v[84:87], v[60:63], v[32:35]
    v_mfma_f32_16x16x32_bf16 v[36:39], v[84:87], v[56:59], v[36:39]
    v_mfma_f32_16x16x32_bf16 v[40:43], v[84:87], v[52:55], v[40:43]
    v_mfma_f32_16x16x32_bf16 v[44:47], v[84:87], v[48:51], v[44:47]
    s_waitcnt vmcnt(16)
    v_mfma_f32_16x16x32_bf16 v[16:19], v[88:91], v[80:83], v[16:19]
    v_mfma_f32_16x16x32_bf16 v[20:23], v[88:91], v[76:79], v[20:23]
    v_mfma_f32_16x16x32_bf16 v[24:27], v[88:91], v[72:75], v[24:27]
    v_mfma_f32_16x16x32_bf16 v[28:31], v[88:91], v[68:71], v[28:31]
    v_mfma_f32_16x16x32_bf16 v[32:35], v[88:91], v[64:67], v[32:35]
    v_mfma_f32_16x16x32_bf16 v[36:39], v[88:91], v[60:63], v[36:39]
    v_mfma_f32_16x16x32_bf16 v[40:43], v[88:91], v[56:59], v[40:43]
    v_mfma_f32_16x16x32_bf16 v[44:47], v[88:91], v[52:55], v[44:47]
    s_waitcnt vmcnt(15)
    v_mfma_f32_16x16x32_bf16 v[20:23], v[92:95], v[80:83], v[20:23]
    v_mfma_f32_16x16x32_bf16 v[24:27], v[92:95], v[76:79], v[24:27]
    v_mfma_f32_16x16x32_bf16 v[28:31], v[92:95], v[72:75], v[28:31]
    v_mfma_f32_16x16x32_bf16 v[32:35], v[92:95], v[68:71], v[32:35]
    v_mfma_f32_16x16x32_bf16 v[36:39], v[92:95], v[64:67], v[36:39]
    v_mfma_f32_16x16x32_bf16 v[40:43], v[92:95], v[60:63], v[40:43]
    v_mfma_f32_16x16x32_bf16 v[44:47], v[92:95], v[56:59], v[44:47]
    s_waitcnt vmcnt(14)
    v_mfma_f32_16x16x32_bf16 v[24:27], v[96:99], v[80:83], v[24:27]
    v_mfma_f32_16x16x32_bf16 v[28:31], v[96:99], v[76:79], v[28:31]
    v_mfma_f32_16x16x32_bf16 v[32:35], v[96:99], v[72:75], v[32:35]
    v_mfma_f32_16x16x32_bf16 v[36:39], v[96:99], v[68:71], v[36:39]
    v_mfma_f32_16x16x32_bf16 v[40:43], v[96:99], v[64:67], v[40:43]
    v_mfma_f32_16x16x32_bf16 v[44:47], v[96:99], v[60:63], v[44:47]
    s_waitcnt vmcnt(13)
    v_mfma_f32_16x16x32_bf16 v[28:31], v[100:103], v[80:83], v[28:31]
    v_mfma_f32_16x16x32_bf16 v[32:35], v[100:103], v[76:79], v[32:35]
    v_mfma_f32_16x16x32_bf16 v[36:39], v[100:103], v[72:75], v[36:39]
    v_mfma_f32_16x16x32_bf16 v[40:43], v[100:103], v[68:71], v[40:43]
    v_mfma_f32_16x16x32_bf16 v[44:47], v[100:103], v[64:67], v[44:47]
    s_waitcnt vmcnt(12)
    v_mfma_f32_16x16x32_bf16 v[32:35], v[104:107], v[80:83], v[32:35]
    v_mfma_f32_16x16x32_bf16 v[36:39], v[104:107], v[76:79], v[36:39]
    v_mfma_f32_16x16x32_bf16 v[40:43], v[104:107], v[72:75], v[40:43]
    v_mfma_f32_16x16x32_bf16 v[44:47], v[104:107], v[68:71], v[44:47]
    s_waitcnt vmcnt(11)
    v_mfma_f32_16x16x32_bf16 v[36:39], v[108:111], v[80:83], v[36:39]
    v_mfma_f32_16x16x32_bf16 v[40:43], v[108:111], v[76:79], v[40:43]
    v_mfma_f32_16x16x32_bf16 v[44:47], v[108:111], v[72:75], v[44:47]
    s_waitcnt vmcnt(10)
    v_mfma_f32_16x16x32_bf16 v[40:43], v[112:115], v[80:83], v[40:43]
    v_mfma_f32_16x16x32_bf16 v[44:47], v[112:115], v[76:79], v[44:47]
    s_waitcnt vmcnt(9)
    v_mfma_f32_16x16x32_bf16 v[44:47], v[116:119], v[80:83], v[44:47]
    v_add_u32 v13, 64, v13
    ds_read_b128 v[48:51], v13 offset:512
    ds_read_b128 v[52:55], v13 offset:1024
    ds_read_b128 v[56:59], v13 offset:1536
    ds_read_b128 v[60:63], v13 offset:2048
    ds_read_b128 v[64:67], v13 offset:2560
    ds_read_b128 v[68:71], v13 offset:3072
    ds_read_b128 v[72:75], v13 offset:3584
    ds_read_b128 v[76:79], v13 offset:4096
    ds_read_b128 v[80:83], v13 offset:4608
    buffer_load_dwordx4 v[84:87], v12, s[20:23], 0 offen offset:0
    buffer_load_dwordx4 v[88:91], v12, s[20:23], 0 offen offset:512
    buffer_load_dwordx4 v[92:95], v12, s[20:23], 0 offen offset:1024
    buffer_load_dwordx4 v[96:99], v12, s[20:23], 0 offen offset:1536
    buffer_load_dwordx4 v[100:103], v12, s[20:23], 0 offen offset:2048
    buffer_load_dwordx4 v[104:107], v12, s[20:23], 0 offen offset:2560
    buffer_load_dwordx4 v[108:111], v12, s[20:23], 0 offen offset:3072
    buffer_load_dwordx4 v[112:115], v12, s[20:23], 0 offen offset:3584
    v_add_u32 v15, 4096, v12
    buffer_load_dwordx4 v[116:119], v15, s[20:23], 0 offen
    v_add_u32 v12, 64, v12
    s_waitcnt lgkmcnt(0)
    s_waitcnt vmcnt(17)
    v_mfma_f32_16x16x32_bf16 v[16:19], v[120:123], v[76:79], v[16:19]
    v_mfma_f32_16x16x32_bf16 v[20:23], v[120:123], v[72:75], v[20:23]
    v_mfma_f32_16x16x32_bf16 v[24:27], v[120:123], v[68:71], v[24:27]
    v_mfma_f32_16x16x32_bf16 v[28:31], v[120:123], v[64:67], v[28:31]
    v_mfma_f32_16x16x32_bf16 v[32:35], v[120:123], v[60:63], v[32:35]
    v_mfma_f32_16x16x32_bf16 v[36:39], v[120:123], v[56:59], v[36:39]
    v_mfma_f32_16x16x32_bf16 v[40:43], v[120:123], v[52:55], v[40:43]
    v_mfma_f32_16x16x32_bf16 v[44:47], v[120:123], v[48:51], v[44:47]
    s_waitcnt vmcnt(16)
    v_mfma_f32_16x16x32_bf16 v[16:19], v[124:127], v[80:83], v[16:19]
    v_mfma_f32_16x16x32_bf16 v[20:23], v[124:127], v[76:79], v[20:23]
    v_mfma_f32_16x16x32_bf16 v[24:27], v[124:127], v[72:75], v[24:27]
    v_mfma_f32_16x16x32_bf16 v[28:31], v[124:127], v[68:71], v[28:31]
    v_mfma_f32_16x16x32_bf16 v[32:35], v[124:127], v[64:67], v[32:35]
    v_mfma_f32_16x16x32_bf16 v[36:39], v[124:127], v[60:63], v[36:39]
    v_mfma_f32_16x16x32_bf16 v[40:43], v[124:127], v[56:59], v[40:43]
    v_mfma_f32_16x16x32_bf16 v[44:47], v[124:127], v[52:55], v[44:47]
    s_waitcnt vmcnt(15)
    v_mfma_f32_16x16x32_bf16 v[20:23], v[128:131], v[80:83], v[20:23]
    v_mfma_f32_16x16x32_bf16 v[24:27], v[128:131], v[76:79], v[24:27]
    v_mfma_f32_16x16x32_bf16 v[28:31], v[128:131], v[72:75], v[28:31]
    v_mfma_f32_16x16x32_bf16 v[32:35], v[128:131], v[68:71], v[32:35]
    v_mfma_f32_16x16x32_bf16 v[36:39], v[128:131], v[64:67], v[36:39]
    v_mfma_f32_16x16x32_bf16 v[40:43], v[128:131], v[60:63], v[40:43]
    v_mfma_f32_16x16x32_bf16 v[44:47], v[128:131], v[56:59], v[44:47]
    s_waitcnt vmcnt(14)
    v_mfma_f32_16x16x32_bf16 v[24:27], v[132:135], v[80:83], v[24:27]
    v_mfma_f32_16x16x32_bf16 v[28:31], v[132:135], v[76:79], v[28:31]
    v_mfma_f32_16x16x32_bf16 v[32:35], v[132:135], v[72:75], v[32:35]
    v_mfma_f32_16x16x32_bf16 v[36:39], v[132:135], v[68:71], v[36:39]
    v_mfma_f32_16x16x32_bf16 v[40:43], v[132:135], v[64:67], v[40:43]
    v_mfma_f32_16x16x32_bf16 v[44:47], v[132:135], v[60:63], v[44:47]
    s_waitcnt vmcnt(13)
    v_mfma_f32_16x16x32_bf16 v[28:31], v[136:139], v[80:83], v[28:31]
    v_mfma_f32_16x16x32_bf16 v[32:35], v[136:139], v[76:79], v[32:35]
    v_mfma_f32_16x16x32_bf16 v[36:39], v[136:139], v[72:75], v[36:39]
    v_mfma_f32_16x16x32_bf16 v[40:43], v[136:139], v[68:71], v[40:43]
    v_mfma_f32_16x16x32_bf16 v[44:47], v[136:139], v[64:67], v[44:47]
    s_waitcnt vmcnt(12)
    v_mfma_f32_16x16x32_bf16 v[32:35], v[140:143], v[80:83], v[32:35]
    v_mfma_f32_16x16x32_bf16 v[36:39], v[140:143], v[76:79], v[36:39]
    v_mfma_f32_16x16x32_bf16 v[40:43], v[140:143], v[72:75], v[40:43]
    v_mfma_f32_16x16x32_bf16 v[44:47], v[140:143], v[68:71], v[44:47]
    s_waitcnt vmcnt(11)
    v_mfma_f32_16x16x32_bf16 v[36:39], v[144:147], v[80:83], v[36:39]
    v_mfma_f32_16x16x32_bf16 v[40:43], v[144:147], v[76:79], v[40:43]
    v_mfma_f32_16x16x32_bf16 v[44:47], v[144:147], v[72:75], v[44:47]
    s_waitcnt vmcnt(10)
    v_mfma_f32_16x16x32_bf16 v[40:43], v[148:151], v[80:83], v[40:43]
    v_mfma_f32_16x16x32_bf16 v[44:47], v[148:151], v[76:79], v[44:47]
    s_waitcnt vmcnt(9)
    v_mfma_f32_16x16x32_bf16 v[44:47], v[152:155], v[80:83], v[44:47]
    v_add_u32 v13, 64, v13
    s_add_u32 s41, s41, 1
    s_cmp_lt_u32 s41, 4
    s_cbranch_scc1 k0_kernel_rl
    s_waitcnt vmcnt(0)
    v_lshlrev_b32 v6, 1, v6
    buffer_load_ushort v15, v6, s[24:27], 0 offen
    v_lshlrev_b32 v10, 4, v10
    v_lshl_add_u32 v10, v11, 2, v10
    v_lshlrev_b32 v11, 1, v10
    v_sub_u32 v11, 536, v11
    v_add_u32 v11, v7, v11
    v_lshlrev_b32 v12, 3, v10
    v_lshl_add_u32 v12, v4, 1, v12
    ds_read_b64 v[84:85], v11 offset:3584
    ds_read_u16 v100, v11 offset:3592
    ds_read_b64 v[86:87], v11 offset:3072
    ds_read_u16 v101, v11 offset:3080
    ds_read_b64 v[88:89], v11 offset:2560
    ds_read_u16 v102, v11 offset:2568
    ds_read_b64 v[90:91], v11 offset:2048
    ds_read_u16 v103, v11 offset:2056
    ds_read_b64 v[92:93], v11 offset:1536
    ds_read_u16 v104, v11 offset:1544
    ds_read_b64 v[94:95], v11 offset:1024
    ds_read_u16 v105, v11 offset:1032
    ds_read_b64 v[96:97], v11 offset:512
    ds_read_u16 v106, v11 offset:520
    ds_read_b64 v[98:99], v11 offset:0
    ds_read_u16 v107, v11 offset:8
    s_waitcnt vmcnt(0) lgkmcnt(0)
    v_lshlrev_b32 v15, 16, v15
    v_lshlrev_b32 v50, 16, v100
    v_and_b32 v51, 0xffff0000, v85
    v_lshlrev_b32 v52, 16, v85
    v_and_b32 v53, 0xffff0000, v84
    v_mul_f32 v50, v50, v15
    v_cvt_pk_bf16_f32 v50, v50, v50
    v_lshlrev_b32 v50, 16, v50
    v_cvt_pk_bf16_f32 v16, v16, v16
    v_lshlrev_b32 v16, 16, v16
    v_add_f32 v50, v50, v16
    v_cvt_pk_bf16_f32 v50, v50, v50
    ds_write_b16 v12, v50 offset:20480
    v_mul_f32 v51, v51, v15
    v_cvt_pk_bf16_f32 v51, v51, v51
    v_lshlrev_b32 v51, 16, v51
    v_cvt_pk_bf16_f32 v17, v17, v17
    v_lshlrev_b32 v17, 16, v17
    v_add_f32 v51, v51, v17
    v_cvt_pk_bf16_f32 v51, v51, v51
    ds_write_b16 v12, v51 offset:20488
    v_mul_f32 v52, v52, v15
    v_cvt_pk_bf16_f32 v52, v52, v52
    v_lshlrev_b32 v52, 16, v52
    v_cvt_pk_bf16_f32 v18, v18, v18
    v_lshlrev_b32 v18, 16, v18
    v_add_f32 v52, v52, v18
    v_cvt_pk_bf16_f32 v52, v52, v52
    ds_write_b16 v12, v52 offset:20496
    v_mul_f32 v53, v53, v15
    v_cvt_pk_bf16_f32 v53, v53, v53
    v_lshlrev_b32 v53, 16, v53
    v_cvt_pk_bf16_f32 v19, v19, v19
    v_lshlrev_b32 v19, 16, v19
    v_add_f32 v53, v53, v19
    v_cvt_pk_bf16_f32 v53, v53, v53
    ds_write_b16 v12, v53 offset:20504
    v_lshlrev_b32 v50, 16, v101
    v_and_b32 v51, 0xffff0000, v87
    v_lshlrev_b32 v52, 16, v87
    v_and_b32 v53, 0xffff0000, v86
    v_mul_f32 v50, v50, v15
    v_cvt_pk_bf16_f32 v50, v50, v50
    v_lshlrev_b32 v50, 16, v50
    v_cvt_pk_bf16_f32 v20, v20, v20
    v_lshlrev_b32 v20, 16, v20
    v_add_f32 v50, v50, v20
    v_cvt_pk_bf16_f32 v50, v50, v50
    ds_write_b16 v12, v50 offset:22528
    v_mul_f32 v51, v51, v15
    v_cvt_pk_bf16_f32 v51, v51, v51
    v_lshlrev_b32 v51, 16, v51
    v_cvt_pk_bf16_f32 v21, v21, v21
    v_lshlrev_b32 v21, 16, v21
    v_add_f32 v51, v51, v21
    v_cvt_pk_bf16_f32 v51, v51, v51
    ds_write_b16 v12, v51 offset:22536
    v_mul_f32 v52, v52, v15
    v_cvt_pk_bf16_f32 v52, v52, v52
    v_lshlrev_b32 v52, 16, v52
    v_cvt_pk_bf16_f32 v22, v22, v22
    v_lshlrev_b32 v22, 16, v22
    v_add_f32 v52, v52, v22
    v_cvt_pk_bf16_f32 v52, v52, v52
    ds_write_b16 v12, v52 offset:22544
    v_mul_f32 v53, v53, v15
    v_cvt_pk_bf16_f32 v53, v53, v53
    v_lshlrev_b32 v53, 16, v53
    v_cvt_pk_bf16_f32 v23, v23, v23
    v_lshlrev_b32 v23, 16, v23
    v_add_f32 v53, v53, v23
    v_cvt_pk_bf16_f32 v53, v53, v53
    ds_write_b16 v12, v53 offset:22552
    v_lshlrev_b32 v50, 16, v102
    v_and_b32 v51, 0xffff0000, v89
    v_lshlrev_b32 v52, 16, v89
    v_and_b32 v53, 0xffff0000, v88
    v_mul_f32 v50, v50, v15
    v_cvt_pk_bf16_f32 v50, v50, v50
    v_lshlrev_b32 v50, 16, v50
    v_cvt_pk_bf16_f32 v24, v24, v24
    v_lshlrev_b32 v24, 16, v24
    v_add_f32 v50, v50, v24
    v_cvt_pk_bf16_f32 v50, v50, v50
    ds_write_b16 v12, v50 offset:24576
    v_mul_f32 v51, v51, v15
    v_cvt_pk_bf16_f32 v51, v51, v51
    v_lshlrev_b32 v51, 16, v51
    v_cvt_pk_bf16_f32 v25, v25, v25
    v_lshlrev_b32 v25, 16, v25
    v_add_f32 v51, v51, v25
    v_cvt_pk_bf16_f32 v51, v51, v51
    ds_write_b16 v12, v51 offset:24584
    v_mul_f32 v52, v52, v15
    v_cvt_pk_bf16_f32 v52, v52, v52
    v_lshlrev_b32 v52, 16, v52
    v_cvt_pk_bf16_f32 v26, v26, v26
    v_lshlrev_b32 v26, 16, v26
    v_add_f32 v52, v52, v26
    v_cvt_pk_bf16_f32 v52, v52, v52
    ds_write_b16 v12, v52 offset:24592
    v_mul_f32 v53, v53, v15
    v_cvt_pk_bf16_f32 v53, v53, v53
    v_lshlrev_b32 v53, 16, v53
    v_cvt_pk_bf16_f32 v27, v27, v27
    v_lshlrev_b32 v27, 16, v27
    v_add_f32 v53, v53, v27
    v_cvt_pk_bf16_f32 v53, v53, v53
    ds_write_b16 v12, v53 offset:24600
    v_lshlrev_b32 v50, 16, v103
    v_and_b32 v51, 0xffff0000, v91
    v_lshlrev_b32 v52, 16, v91
    v_and_b32 v53, 0xffff0000, v90
    v_mul_f32 v50, v50, v15
    v_cvt_pk_bf16_f32 v50, v50, v50
    v_lshlrev_b32 v50, 16, v50
    v_cvt_pk_bf16_f32 v28, v28, v28
    v_lshlrev_b32 v28, 16, v28
    v_add_f32 v50, v50, v28
    v_cvt_pk_bf16_f32 v50, v50, v50
    ds_write_b16 v12, v50 offset:26624
    v_mul_f32 v51, v51, v15
    v_cvt_pk_bf16_f32 v51, v51, v51
    v_lshlrev_b32 v51, 16, v51
    v_cvt_pk_bf16_f32 v29, v29, v29
    v_lshlrev_b32 v29, 16, v29
    v_add_f32 v51, v51, v29
    v_cvt_pk_bf16_f32 v51, v51, v51
    ds_write_b16 v12, v51 offset:26632
    v_mul_f32 v52, v52, v15
    v_cvt_pk_bf16_f32 v52, v52, v52
    v_lshlrev_b32 v52, 16, v52
    v_cvt_pk_bf16_f32 v30, v30, v30
    v_lshlrev_b32 v30, 16, v30
    v_add_f32 v52, v52, v30
    v_cvt_pk_bf16_f32 v52, v52, v52
    ds_write_b16 v12, v52 offset:26640
    v_mul_f32 v53, v53, v15
    v_cvt_pk_bf16_f32 v53, v53, v53
    v_lshlrev_b32 v53, 16, v53
    v_cvt_pk_bf16_f32 v31, v31, v31
    v_lshlrev_b32 v31, 16, v31
    v_add_f32 v53, v53, v31
    v_cvt_pk_bf16_f32 v53, v53, v53
    ds_write_b16 v12, v53 offset:26648
    v_lshlrev_b32 v50, 16, v104
    v_and_b32 v51, 0xffff0000, v93
    v_lshlrev_b32 v52, 16, v93
    v_and_b32 v53, 0xffff0000, v92
    v_mul_f32 v50, v50, v15
    v_cvt_pk_bf16_f32 v50, v50, v50
    v_lshlrev_b32 v50, 16, v50
    v_cvt_pk_bf16_f32 v32, v32, v32
    v_lshlrev_b32 v32, 16, v32
    v_add_f32 v50, v50, v32
    v_cvt_pk_bf16_f32 v50, v50, v50
    ds_write_b16 v12, v50 offset:28672
    v_mul_f32 v51, v51, v15
    v_cvt_pk_bf16_f32 v51, v51, v51
    v_lshlrev_b32 v51, 16, v51
    v_cvt_pk_bf16_f32 v33, v33, v33
    v_lshlrev_b32 v33, 16, v33
    v_add_f32 v51, v51, v33
    v_cvt_pk_bf16_f32 v51, v51, v51
    ds_write_b16 v12, v51 offset:28680
    v_mul_f32 v52, v52, v15
    v_cvt_pk_bf16_f32 v52, v52, v52
    v_lshlrev_b32 v52, 16, v52
    v_cvt_pk_bf16_f32 v34, v34, v34
    v_lshlrev_b32 v34, 16, v34
    v_add_f32 v52, v52, v34
    v_cvt_pk_bf16_f32 v52, v52, v52
    ds_write_b16 v12, v52 offset:28688
    v_mul_f32 v53, v53, v15
    v_cvt_pk_bf16_f32 v53, v53, v53
    v_lshlrev_b32 v53, 16, v53
    v_cvt_pk_bf16_f32 v35, v35, v35
    v_lshlrev_b32 v35, 16, v35
    v_add_f32 v53, v53, v35
    v_cvt_pk_bf16_f32 v53, v53, v53
    ds_write_b16 v12, v53 offset:28696
    v_lshlrev_b32 v50, 16, v105
    v_and_b32 v51, 0xffff0000, v95
    v_lshlrev_b32 v52, 16, v95
    v_and_b32 v53, 0xffff0000, v94
    v_mul_f32 v50, v50, v15
    v_cvt_pk_bf16_f32 v50, v50, v50
    v_lshlrev_b32 v50, 16, v50
    v_cvt_pk_bf16_f32 v36, v36, v36
    v_lshlrev_b32 v36, 16, v36
    v_add_f32 v50, v50, v36
    v_cvt_pk_bf16_f32 v50, v50, v50
    ds_write_b16 v12, v50 offset:30720
    v_mul_f32 v51, v51, v15
    v_cvt_pk_bf16_f32 v51, v51, v51
    v_lshlrev_b32 v51, 16, v51
    v_cvt_pk_bf16_f32 v37, v37, v37
    v_lshlrev_b32 v37, 16, v37
    v_add_f32 v51, v51, v37
    v_cvt_pk_bf16_f32 v51, v51, v51
    ds_write_b16 v12, v51 offset:30728
    v_mul_f32 v52, v52, v15
    v_cvt_pk_bf16_f32 v52, v52, v52
    v_lshlrev_b32 v52, 16, v52
    v_cvt_pk_bf16_f32 v38, v38, v38
    v_lshlrev_b32 v38, 16, v38
    v_add_f32 v52, v52, v38
    v_cvt_pk_bf16_f32 v52, v52, v52
    ds_write_b16 v12, v52 offset:30736
    v_mul_f32 v53, v53, v15
    v_cvt_pk_bf16_f32 v53, v53, v53
    v_lshlrev_b32 v53, 16, v53
    v_cvt_pk_bf16_f32 v39, v39, v39
    v_lshlrev_b32 v39, 16, v39
    v_add_f32 v53, v53, v39
    v_cvt_pk_bf16_f32 v53, v53, v53
    ds_write_b16 v12, v53 offset:30744
    v_lshlrev_b32 v50, 16, v106
    v_and_b32 v51, 0xffff0000, v97
    v_lshlrev_b32 v52, 16, v97
    v_and_b32 v53, 0xffff0000, v96
    v_mul_f32 v50, v50, v15
    v_cvt_pk_bf16_f32 v50, v50, v50
    v_lshlrev_b32 v50, 16, v50
    v_cvt_pk_bf16_f32 v40, v40, v40
    v_lshlrev_b32 v40, 16, v40
    v_add_f32 v50, v50, v40
    v_cvt_pk_bf16_f32 v50, v50, v50
    ds_write_b16 v12, v50 offset:32768
    v_mul_f32 v51, v51, v15
    v_cvt_pk_bf16_f32 v51, v51, v51
    v_lshlrev_b32 v51, 16, v51
    v_cvt_pk_bf16_f32 v41, v41, v41
    v_lshlrev_b32 v41, 16, v41
    v_add_f32 v51, v51, v41
    v_cvt_pk_bf16_f32 v51, v51, v51
    ds_write_b16 v12, v51 offset:32776
    v_mul_f32 v52, v52, v15
    v_cvt_pk_bf16_f32 v52, v52, v52
    v_lshlrev_b32 v52, 16, v52
    v_cvt_pk_bf16_f32 v42, v42, v42
    v_lshlrev_b32 v42, 16, v42
    v_add_f32 v52, v52, v42
    v_cvt_pk_bf16_f32 v52, v52, v52
    ds_write_b16 v12, v52 offset:32784
    v_mul_f32 v53, v53, v15
    v_cvt_pk_bf16_f32 v53, v53, v53
    v_lshlrev_b32 v53, 16, v53
    v_cvt_pk_bf16_f32 v43, v43, v43
    v_lshlrev_b32 v43, 16, v43
    v_add_f32 v53, v53, v43
    v_cvt_pk_bf16_f32 v53, v53, v53
    ds_write_b16 v12, v53 offset:32792
    v_lshlrev_b32 v50, 16, v107
    v_and_b32 v51, 0xffff0000, v99
    v_lshlrev_b32 v52, 16, v99
    v_and_b32 v53, 0xffff0000, v98
    v_mul_f32 v50, v50, v15
    v_cvt_pk_bf16_f32 v50, v50, v50
    v_lshlrev_b32 v50, 16, v50
    v_cvt_pk_bf16_f32 v44, v44, v44
    v_lshlrev_b32 v44, 16, v44
    v_add_f32 v50, v50, v44
    v_cvt_pk_bf16_f32 v50, v50, v50
    ds_write_b16 v12, v50 offset:34816
    v_mul_f32 v51, v51, v15
    v_cvt_pk_bf16_f32 v51, v51, v51
    v_lshlrev_b32 v51, 16, v51
    v_cvt_pk_bf16_f32 v45, v45, v45
    v_lshlrev_b32 v45, 16, v45
    v_add_f32 v51, v51, v45
    v_cvt_pk_bf16_f32 v51, v51, v51
    ds_write_b16 v12, v51 offset:34824
    v_mul_f32 v52, v52, v15
    v_cvt_pk_bf16_f32 v52, v52, v52
    v_lshlrev_b32 v52, 16, v52
    v_cvt_pk_bf16_f32 v46, v46, v46
    v_lshlrev_b32 v46, 16, v46
    v_add_f32 v52, v52, v46
    v_cvt_pk_bf16_f32 v52, v52, v52
    ds_write_b16 v12, v52 offset:34832
    v_mul_f32 v53, v53, v15
    v_cvt_pk_bf16_f32 v53, v53, v53
    v_lshlrev_b32 v53, 16, v53
    v_cvt_pk_bf16_f32 v47, v47, v47
    v_lshlrev_b32 v47, 16, v47
    v_add_f32 v53, v53, v47
    v_cvt_pk_bf16_f32 v53, v53, v53
    ds_write_b16 v12, v53 offset:34840
    s_waitcnt lgkmcnt(0)
    s_barrier
    v_add_u32 v2, s3, v1
    ds_read_b128 v[16:19], v1 offset:20480
    ds_read_b128 v[20:23], v1 offset:24576
    ds_read_b128 v[24:27], v1 offset:28672
    ds_read_b128 v[28:31], v1 offset:32768
    s_waitcnt lgkmcnt(0)
    buffer_store_dwordx4 v[16:19], v2, s[36:39], 0 offen
    v_add_u32 v2, 4096, v2
    buffer_store_dwordx4 v[20:23], v2, s[36:39], 0 offen
    v_add_u32 v2, 4096, v2
    buffer_store_dwordx4 v[24:27], v2, s[36:39], 0 offen
    v_add_u32 v2, 4096, v2
    buffer_store_dwordx4 v[28:31], v2, s[36:39], 0 offen
    v_add_u32 v2, 4096, v2
k0_kernel_end:
    s_endpgm
.globl k1_kernel
.p2align 8
.type k1_kernel,@function
k1_kernel:
    s_cmp_ge_u32 s2, 512
    s_cbranch_scc1 k1_kernel_end
    s_load_dwordx2 s[4:5], s[0:1], 0
    s_load_dwordx2 s[6:7], s[0:1], 96
    v_lshrrev_b32 v1, 4, v0
    v_and_b32 v2, 15, v0
    v_lshl_add_u32 v1, s2, 2, v1
    v_mul_u32_u24 v3, 1280, v1
    v_lshl_add_u32 v3, v2, 4, v3
    s_waitcnt lgkmcnt(0)
    s_add_u32 s8, s4, 0
    s_addc_u32 s9, s5, 0
    s_and_b32 s9, s9, 0xffff
    s_mov_b32 s10, 2621440
    s_mov_b32 s11, 0x00020000
    s_add_u32 s12, s6, 7340032
    s_addc_u32 s13, s7, 0
    s_and_b32 s13, s13, 0xffff
    s_mov_b32 s14, 2621440
    s_mov_b32 s15, 0x00020000
    s_add_u32 s16, s6, 10485760
    s_addc_u32 s17, s7, 0
    s_and_b32 s17, s17, 0xffff
    s_mov_b32 s18, 2621440
    s_mov_b32 s19, 0x00020000
    s_add_u32 s20, s6, 19922944
    s_addc_u32 s21, s7, 0
    s_and_b32 s21, s21, 0xffff
    s_mov_b32 s22, 2703360
    s_mov_b32 s23, 0x00020000
    buffer_load_dwordx4 v[140:143], v3, s[8:11], 0 offen offset:0
    buffer_load_dwordx4 v[144:147], v3, s[8:11], 0 offen offset:256
    buffer_load_dwordx4 v[148:151], v3, s[8:11], 0 offen offset:512
    buffer_load_dwordx4 v[152:155], v3, s[8:11], 0 offen offset:768
    buffer_load_dwordx4 v[156:159], v3, s[8:11], 0 offen offset:1024
    v_lshlrev_b32 v6, 15, v2
    v_lshl_add_u32 v6, v1, 3, v6
    buffer_load_dwordx2 v[160:161], v6, s[12:15], 0 offen
    v_add_u32 v6, 16384, v6
    buffer_load_dwordx2 v[162:163], v6, s[12:15], 0 offen
    v_add_u32 v6, 507904, v6
    buffer_load_dwordx2 v[164:165], v6, s[12:15], 0 offen
    v_add_u32 v6, 16384, v6
    buffer_load_dwordx2 v[166:167], v6, s[12:15], 0 offen
    v_add_u32 v6, 507904, v6
    buffer_load_dwordx2 v[168:169], v6, s[12:15], 0 offen
    v_add_u32 v6, 16384, v6
    buffer_load_dwordx2 v[170:171], v6, s[12:15], 0 offen
    v_add_u32 v6, 507904, v6
    buffer_load_dwordx2 v[172:173], v6, s[12:15], 0 offen
    v_add_u32 v6, 16384, v6
    buffer_load_dwordx2 v[174:175], v6, s[12:15], 0 offen
    v_add_u32 v6, 507904, v6
    buffer_load_dwordx2 v[176:177], v6, s[12:15], 0 offen
    v_add_u32 v6, 16384, v6
    buffer_load_dwordx2 v[178:179], v6, s[12:15], 0 offen
    v_add_u32 v6, 507904, v6
    s_waitcnt vmcnt(10)
    v_lshlrev_b32 v10, 16, v140
    v_and_b32 v11, 0xffff0000, v140
    v_lshlrev_b32 v12, 16, v141
    v_and_b32 v13, 0xffff0000, v141
    v_lshlrev_b32 v14, 16, v142
    v_and_b32 v15, 0xffff0000, v142
    v_lshlrev_b32 v16, 16, v143
    v_and_b32 v17, 0xffff0000, v143
    v_lshlrev_b32 v18, 16, v144
    v_and_b32 v19, 0xffff0000, v144
    v_lshlrev_b32 v20, 16, v145
    v_and_b32 v21, 0xffff0000, v145
    v_lshlrev_b32 v22, 16, v146
    v_and_b32 v23, 0xffff0000, v146
    v_lshlrev_b32 v24, 16, v147
    v_and_b32 v25, 0xffff0000, v147
    v_lshlrev_b32 v26, 16, v148
    v_and_b32 v27, 0xffff0000, v148
    v_lshlrev_b32 v28, 16, v149
    v_and_b32 v29, 0xffff0000, v149
    v_lshlrev_b32 v30, 16, v150
    v_and_b32 v31, 0xffff0000, v150
    v_lshlrev_b32 v32, 16, v151
    v_and_b32 v33, 0xffff0000, v151
    v_lshlrev_b32 v34, 16, v152
    v_and_b32 v35, 0xffff0000, v152
    v_lshlrev_b32 v36, 16, v153
    v_and_b32 v37, 0xffff0000, v153
    v_lshlrev_b32 v38, 16, v154
    v_and_b32 v39, 0xffff0000, v154
    v_lshlrev_b32 v40, 16, v155
    v_and_b32 v41, 0xffff0000, v155
    v_lshlrev_b32 v42, 16, v156
    v_and_b32 v43, 0xffff0000, v156
    v_lshlrev_b32 v44, 16, v157
    v_and_b32 v45, 0xffff0000, v157
    v_lshlrev_b32 v46, 16, v158
    v_and_b32 v47, 0xffff0000, v158
    v_lshlrev_b32 v48, 16, v159
    v_and_b32 v49, 0xffff0000, v159
    v_mov_b32 v90, v10
    v_add_f32 v90, v90, v11
    v_add_f32 v90, v90, v12
    v_add_f32 v90, v90, v13
    v_add_f32 v90, v90, v14
    v_add_f32 v90, v90, v15
    v_add_f32 v90, v90, v16
    v_add_f32 v90, v90, v17
    v_add_f32 v90, v90, v18
    v_add_f32 v90, v90, v19
    v_add_f32 v90, v90, v20
    v_add_f32 v90, v90, v21
    v_add_f32 v90, v90, v22
    v_add_f32 v90, v90, v23
    v_add_f32 v90, v90, v24
    v_add_f32 v90, v90, v25
    v_add_f32 v90, v90, v26
    v_add_f32 v90, v90, v27
    v_add_f32 v90, v90, v28
    v_add_f32 v90, v90, v29
    v_add_f32 v90, v90, v30
    v_add_f32 v90, v90, v31
    v_add_f32 v90, v90, v32
    v_add_f32 v90, v90, v33
    v_add_f32 v90, v90, v34
    v_add_f32 v90, v90, v35
    v_add_f32 v90, v90, v36
    v_add_f32 v90, v90, v37
    v_add_f32 v90, v90, v38
    v_add_f32 v90, v90, v39
    v_add_f32 v90, v90, v40
    v_add_f32 v90, v90, v41
    v_add_f32 v90, v90, v42
    v_add_f32 v90, v90, v43
    v_add_f32 v90, v90, v44
    v_add_f32 v90, v90, v45
    v_add_f32 v90, v90, v46
    v_add_f32 v90, v90, v47
    v_add_f32 v90, v90, v48
    v_add_f32 v90, v90, v49
    s_nop 1
    v_add_f32_dpp v90, v90, v90 row_ror:8 row_mask:0xf bank_mask:0xf
    s_nop 1
    v_add_f32_dpp v90, v90, v90 row_ror:4 row_mask:0xf bank_mask:0xf
    s_nop 1
    v_add_f32_dpp v90, v90, v90 row_ror:2 row_mask:0xf bank_mask:0xf
    s_nop 1
    v_add_f32_dpp v90, v90, v90 row_ror:1 row_mask:0xf bank_mask:0xf
    v_mul_f32 v90, 0.0015625, v90
    v_mov_b32 v91, 0
    v_sub_f32 v92, v10, v90
    v_fmac_f32 v91, v92, v92
    v_sub_f32 v92, v11, v90
    v_fmac_f32 v91, v92, v92
    v_sub_f32 v92, v12, v90
    v_fmac_f32 v91, v92, v92
    v_sub_f32 v92, v13, v90
    v_fmac_f32 v91, v92, v92
    v_sub_f32 v92, v14, v90
    v_fmac_f32 v91, v92, v92
    v_sub_f32 v92, v15, v90
    v_fmac_f32 v91, v92, v92
    v_sub_f32 v92, v16, v90
    v_fmac_f32 v91, v92, v92
    v_sub_f32 v92, v17, v90
    v_fmac_f32 v91, v92, v92
    v_sub_f32 v92, v18, v90
    v_fmac_f32 v91, v92, v92
    v_sub_f32 v92, v19, v90
    v_fmac_f32 v91, v92, v92
    v_sub_f32 v92, v20, v90
    v_fmac_f32 v91, v92, v92
    v_sub_f32 v92, v21, v90
    v_fmac_f32 v91, v92, v92
    v_sub_f32 v92, v22, v90
    v_fmac_f32 v91, v92, v92
    v_sub_f32 v92, v23, v90
    v_fmac_f32 v91, v92, v92
    v_sub_f32 v92, v24, v90
    v_fmac_f32 v91, v92, v92
    v_sub_f32 v92, v25, v90
    v_fmac_f32 v91, v92, v92
    v_sub_f32 v92, v26, v90
    v_fmac_f32 v91, v92, v92
    v_sub_f32 v92, v27, v90
    v_fmac_f32 v91, v92, v92
    v_sub_f32 v92, v28, v90
    v_fmac_f32 v91, v92, v92
    v_sub_f32 v92, v29, v90
    v_fmac_f32 v91, v92, v92
    v_sub_f32 v92, v30, v90
    v_fmac_f32 v91, v92, v92
    v_sub_f32 v92, v31, v90
    v_fmac_f32 v91, v92, v92
    v_sub_f32 v92, v32, v90
    v_fmac_f32 v91, v92, v92
    v_sub_f32 v92, v33, v90
    v_fmac_f32 v91, v92, v92
    v_sub_f32 v92, v34, v90
    v_fmac_f32 v91, v92, v92
    v_sub_f32 v92, v35, v90
    v_fmac_f32 v91, v92, v92
    v_sub_f32 v92, v36, v90
    v_fmac_f32 v91, v92, v92
    v_sub_f32 v92, v37, v90
    v_fmac_f32 v91, v92, v92
    v_sub_f32 v92, v38, v90
    v_fmac_f32 v91, v92, v92
    v_sub_f32 v92, v39, v90
    v_fmac_f32 v91, v92, v92
    v_sub_f32 v92, v40, v90
    v_fmac_f32 v91, v92, v92
    v_sub_f32 v92, v41, v90
    v_fmac_f32 v91, v92, v92
    v_sub_f32 v92, v42, v90
    v_fmac_f32 v91, v92, v92
    v_sub_f32 v92, v43, v90
    v_fmac_f32 v91, v92, v92
    v_sub_f32 v92, v44, v90
    v_fmac_f32 v91, v92, v92
    v_sub_f32 v92, v45, v90
    v_fmac_f32 v91, v92, v92
    v_sub_f32 v92, v46, v90
    v_fmac_f32 v91, v92, v92
    v_sub_f32 v92, v47, v90
    v_fmac_f32 v91, v92, v92
    v_sub_f32 v92, v48, v90
    v_fmac_f32 v91, v92, v92
    v_sub_f32 v92, v49, v90
    v_fmac_f32 v91, v92, v92
    s_nop 1
    v_add_f32_dpp v91, v91, v91 row_ror:8 row_mask:0xf bank_mask:0xf
    s_nop 1
    v_add_f32_dpp v91, v91, v91 row_ror:4 row_mask:0xf bank_mask:0xf
    s_nop 1
    v_add_f32_dpp v91, v91, v91 row_ror:2 row_mask:0xf bank_mask:0xf
    s_nop 1
    v_add_f32_dpp v91, v91, v91 row_ror:1 row_mask:0xf bank_mask:0xf
    v_mul_f32 v91, 0.0015625, v91
    v_cvt_pk_bf16_f32 v91, v91, v91
    v_lshlrev_b32 v91, 16, v91
    v_add_f32 v91, 0x3727c5ac, v91
    v_cvt_pk_bf16_f32 v91, v91, v91
    v_lshlrev_b32 v91, 16, v91
    v_sqrt_f32 v91, v91
    s_nop 0
    v_cvt_pk_bf16_f32 v91, v91, v91
    v_lshlrev_b32 v91, 16, v91
    v_rcp_f32 v91, v91
    v_cvt_pk_bf16_f32 v90, v90, v90
    v_lshlrev_b32 v90, 16, v90
    v_sub_f32 v100, v10, v90
    v_cvt_pk_bf16_f32 v100, v100, v100
    v_lshlrev_b32 v100, 16, v100
    v_mul_f32 v100, v100, v91
    v_cvt_pk_bf16_f32 v100, v100, v100
    v_lshlrev_b32 v100, 16, v100
    v_sub_f32 v101, v11, v90
    v_cvt_pk_bf16_f32 v101, v101, v101
    v_lshlrev_b32 v101, 16, v101
    v_mul_f32 v101, v101, v91
    v_cvt_pk_bf16_f32 v101, v101, v101
    v_lshlrev_b32 v101, 16, v101
    v_sub_f32 v102, v12, v90
    v_cvt_pk_bf16_f32 v102, v102, v102
    v_lshlrev_b32 v102, 16, v102
    v_mul_f32 v102, v102, v91
    v_cvt_pk_bf16_f32 v102, v102, v102
    v_lshlrev_b32 v102, 16, v102
    v_sub_f32 v103, v13, v90
    v_cvt_pk_bf16_f32 v103, v103, v103
    v_lshlrev_b32 v103, 16, v103
    v_mul_f32 v103, v103, v91
    v_cvt_pk_bf16_f32 v103, v103, v103
    v_lshlrev_b32 v103, 16, v103
    v_sub_f32 v104, v14, v90
    v_cvt_pk_bf16_f32 v104, v104, v104
    v_lshlrev_b32 v104, 16, v104
    v_mul_f32 v104, v104, v91
    v_cvt_pk_bf16_f32 v104, v104, v104
    v_lshlrev_b32 v104, 16, v104
    v_sub_f32 v105, v15, v90
    v_cvt_pk_bf16_f32 v105, v105, v105
    v_lshlrev_b32 v105, 16, v105
    v_mul_f32 v105, v105, v91
    v_cvt_pk_bf16_f32 v105, v105, v105
    v_lshlrev_b32 v105, 16, v105
    v_sub_f32 v106, v16, v90
    v_cvt_pk_bf16_f32 v106, v106, v106
    v_lshlrev_b32 v106, 16, v106
    v_mul_f32 v106, v106, v91
    v_cvt_pk_bf16_f32 v106, v106, v106
    v_lshlrev_b32 v106, 16, v106
    v_sub_f32 v107, v17, v90
    v_cvt_pk_bf16_f32 v107, v107, v107
    v_lshlrev_b32 v107, 16, v107
    v_mul_f32 v107, v107, v91
    v_cvt_pk_bf16_f32 v107, v107, v107
    v_lshlrev_b32 v107, 16, v107
    v_sub_f32 v108, v18, v90
    v_cvt_pk_bf16_f32 v108, v108, v108
    v_lshlrev_b32 v108, 16, v108
    v_mul_f32 v108, v108, v91
    v_cvt_pk_bf16_f32 v108, v108, v108
    v_lshlrev_b32 v108, 16, v108
    v_sub_f32 v109, v19, v90
    v_cvt_pk_bf16_f32 v109, v109, v109
    v_lshlrev_b32 v109, 16, v109
    v_mul_f32 v109, v109, v91
    v_cvt_pk_bf16_f32 v109, v109, v109
    v_lshlrev_b32 v109, 16, v109
    v_sub_f32 v110, v20, v90
    v_cvt_pk_bf16_f32 v110, v110, v110
    v_lshlrev_b32 v110, 16, v110
    v_mul_f32 v110, v110, v91
    v_cvt_pk_bf16_f32 v110, v110, v110
    v_lshlrev_b32 v110, 16, v110
    v_sub_f32 v111, v21, v90
    v_cvt_pk_bf16_f32 v111, v111, v111
    v_lshlrev_b32 v111, 16, v111
    v_mul_f32 v111, v111, v91
    v_cvt_pk_bf16_f32 v111, v111, v111
    v_lshlrev_b32 v111, 16, v111
    v_sub_f32 v112, v22, v90
    v_cvt_pk_bf16_f32 v112, v112, v112
    v_lshlrev_b32 v112, 16, v112
    v_mul_f32 v112, v112, v91
    v_cvt_pk_bf16_f32 v112, v112, v112
    v_lshlrev_b32 v112, 16, v112
    v_sub_f32 v113, v23, v90
    v_cvt_pk_bf16_f32 v113, v113, v113
    v_lshlrev_b32 v113, 16, v113
    v_mul_f32 v113, v113, v91
    v_cvt_pk_bf16_f32 v113, v113, v113
    v_lshlrev_b32 v113, 16, v113
    v_sub_f32 v114, v24, v90
    v_cvt_pk_bf16_f32 v114, v114, v114
    v_lshlrev_b32 v114, 16, v114
    v_mul_f32 v114, v114, v91
    v_cvt_pk_bf16_f32 v114, v114, v114
    v_lshlrev_b32 v114, 16, v114
    v_sub_f32 v115, v25, v90
    v_cvt_pk_bf16_f32 v115, v115, v115
    v_lshlrev_b32 v115, 16, v115
    v_mul_f32 v115, v115, v91
    v_cvt_pk_bf16_f32 v115, v115, v115
    v_lshlrev_b32 v115, 16, v115
    v_sub_f32 v116, v26, v90
    v_cvt_pk_bf16_f32 v116, v116, v116
    v_lshlrev_b32 v116, 16, v116
    v_mul_f32 v116, v116, v91
    v_cvt_pk_bf16_f32 v116, v116, v116
    v_lshlrev_b32 v116, 16, v116
    v_sub_f32 v117, v27, v90
    v_cvt_pk_bf16_f32 v117, v117, v117
    v_lshlrev_b32 v117, 16, v117
    v_mul_f32 v117, v117, v91
    v_cvt_pk_bf16_f32 v117, v117, v117
    v_lshlrev_b32 v117, 16, v117
    v_sub_f32 v118, v28, v90
    v_cvt_pk_bf16_f32 v118, v118, v118
    v_lshlrev_b32 v118, 16, v118
    v_mul_f32 v118, v118, v91
    v_cvt_pk_bf16_f32 v118, v118, v118
    v_lshlrev_b32 v118, 16, v118
    v_sub_f32 v119, v29, v90
    v_cvt_pk_bf16_f32 v119, v119, v119
    v_lshlrev_b32 v119, 16, v119
    v_mul_f32 v119, v119, v91
    v_cvt_pk_bf16_f32 v119, v119, v119
    v_lshlrev_b32 v119, 16, v119
    v_sub_f32 v120, v30, v90
    v_cvt_pk_bf16_f32 v120, v120, v120
    v_lshlrev_b32 v120, 16, v120
    v_mul_f32 v120, v120, v91
    v_cvt_pk_bf16_f32 v120, v120, v120
    v_lshlrev_b32 v120, 16, v120
    v_sub_f32 v121, v31, v90
    v_cvt_pk_bf16_f32 v121, v121, v121
    v_lshlrev_b32 v121, 16, v121
    v_mul_f32 v121, v121, v91
    v_cvt_pk_bf16_f32 v121, v121, v121
    v_lshlrev_b32 v121, 16, v121
    v_sub_f32 v122, v32, v90
    v_cvt_pk_bf16_f32 v122, v122, v122
    v_lshlrev_b32 v122, 16, v122
    v_mul_f32 v122, v122, v91
    v_cvt_pk_bf16_f32 v122, v122, v122
    v_lshlrev_b32 v122, 16, v122
    v_sub_f32 v123, v33, v90
    v_cvt_pk_bf16_f32 v123, v123, v123
    v_lshlrev_b32 v123, 16, v123
    v_mul_f32 v123, v123, v91
    v_cvt_pk_bf16_f32 v123, v123, v123
    v_lshlrev_b32 v123, 16, v123
    v_sub_f32 v124, v34, v90
    v_cvt_pk_bf16_f32 v124, v124, v124
    v_lshlrev_b32 v124, 16, v124
    v_mul_f32 v124, v124, v91
    v_cvt_pk_bf16_f32 v124, v124, v124
    v_lshlrev_b32 v124, 16, v124
    v_sub_f32 v125, v35, v90
    v_cvt_pk_bf16_f32 v125, v125, v125
    v_lshlrev_b32 v125, 16, v125
    v_mul_f32 v125, v125, v91
    v_cvt_pk_bf16_f32 v125, v125, v125
    v_lshlrev_b32 v125, 16, v125
    v_sub_f32 v126, v36, v90
    v_cvt_pk_bf16_f32 v126, v126, v126
    v_lshlrev_b32 v126, 16, v126
    v_mul_f32 v126, v126, v91
    v_cvt_pk_bf16_f32 v126, v126, v126
    v_lshlrev_b32 v126, 16, v126
    v_sub_f32 v127, v37, v90
    v_cvt_pk_bf16_f32 v127, v127, v127
    v_lshlrev_b32 v127, 16, v127
    v_mul_f32 v127, v127, v91
    v_cvt_pk_bf16_f32 v127, v127, v127
    v_lshlrev_b32 v127, 16, v127
    v_sub_f32 v128, v38, v90
    v_cvt_pk_bf16_f32 v128, v128, v128
    v_lshlrev_b32 v128, 16, v128
    v_mul_f32 v128, v128, v91
    v_cvt_pk_bf16_f32 v128, v128, v128
    v_lshlrev_b32 v128, 16, v128
    v_sub_f32 v129, v39, v90
    v_cvt_pk_bf16_f32 v129, v129, v129
    v_lshlrev_b32 v129, 16, v129
    v_mul_f32 v129, v129, v91
    v_cvt_pk_bf16_f32 v129, v129, v129
    v_lshlrev_b32 v129, 16, v129
    v_sub_f32 v130, v40, v90
    v_cvt_pk_bf16_f32 v130, v130, v130
    v_lshlrev_b32 v130, 16, v130
    v_mul_f32 v130, v130, v91
    v_cvt_pk_bf16_f32 v130, v130, v130
    v_lshlrev_b32 v130, 16, v130
    v_sub_f32 v131, v41, v90
    v_cvt_pk_bf16_f32 v131, v131, v131
    v_lshlrev_b32 v131, 16, v131
    v_mul_f32 v131, v131, v91
    v_cvt_pk_bf16_f32 v131, v131, v131
    v_lshlrev_b32 v131, 16, v131
    v_sub_f32 v132, v42, v90
    v_cvt_pk_bf16_f32 v132, v132, v132
    v_lshlrev_b32 v132, 16, v132
    v_mul_f32 v132, v132, v91
    v_cvt_pk_bf16_f32 v132, v132, v132
    v_lshlrev_b32 v132, 16, v132
    v_sub_f32 v133, v43, v90
    v_cvt_pk_bf16_f32 v133, v133, v133
    v_lshlrev_b32 v133, 16, v133
    v_mul_f32 v133, v133, v91
    v_cvt_pk_bf16_f32 v133, v133, v133
    v_lshlrev_b32 v133, 16, v133
    v_sub_f32 v134, v44, v90
    v_cvt_pk_bf16_f32 v134, v134, v134
    v_lshlrev_b32 v134, 16, v134
    v_mul_f32 v134, v134, v91
    v_cvt_pk_bf16_f32 v134, v134, v134
    v_lshlrev_b32 v134, 16, v134
    v_sub_f32 v135, v45, v90
    v_cvt_pk_bf16_f32 v135, v135, v135
    v_lshlrev_b32 v135, 16, v135
    v_mul_f32 v135, v135, v91
    v_cvt_pk_bf16_f32 v135, v135, v135
    v_lshlrev_b32 v135, 16, v135
    v_sub_f32 v136, v46, v90
    v_cvt_pk_bf16_f32 v136, v136, v136
    v_lshlrev_b32 v136, 16, v136
    v_mul_f32 v136, v136, v91
    v_cvt_pk_bf16_f32 v136, v136, v136
    v_lshlrev_b32 v136, 16, v136
    v_sub_f32 v137, v47, v90
    v_cvt_pk_bf16_f32 v137, v137, v137
    v_lshlrev_b32 v137, 16, v137
    v_mul_f32 v137, v137, v91
    v_cvt_pk_bf16_f32 v137, v137, v137
    v_lshlrev_b32 v137, 16, v137
    v_sub_f32 v138, v48, v90
    v_cvt_pk_bf16_f32 v138, v138, v138
    v_lshlrev_b32 v138, 16, v138
    v_mul_f32 v138, v138, v91
    v_cvt_pk_bf16_f32 v138, v138, v138
    v_lshlrev_b32 v138, 16, v138
    v_sub_f32 v139, v49, v90
    v_cvt_pk_bf16_f32 v139, v139, v139
    v_lshlrev_b32 v139, 16, v139
    v_mul_f32 v139, v139, v91
    v_cvt_pk_bf16_f32 v139, v139, v139
    v_lshlrev_b32 v139, 16, v139
    s_waitcnt vmcnt(0)
    v_lshlrev_b32 v92, 16, v160
    v_mul_f32 v92, v92, v100
    v_cvt_pk_bf16_f32 v92, v92, v92
    v_lshlrev_b32 v92, 16, v92
    v_add_f32 v10, v10, v92
    v_cvt_pk_bf16_f32 v10, v10, v10
    v_lshlrev_b32 v10, 16, v10
    v_and_b32 v92, 0xffff0000, v160
    v_mul_f32 v92, v92, v101
    v_cvt_pk_bf16_f32 v92, v92, v92
    v_lshlrev_b32 v92, 16, v92
    v_add_f32 v11, v11, v92
    v_cvt_pk_bf16_f32 v11, v11, v11
    v_lshlrev_b32 v11, 16, v11
    v_cvt_pk_bf16_f32 v140, v10, v11
    v_lshlrev_b32 v92, 16, v161
    v_mul_f32 v92, v92, v102
    v_cvt_pk_bf16_f32 v92, v92, v92
    v_lshlrev_b32 v92, 16, v92
    v_add_f32 v12, v12, v92
    v_cvt_pk_bf16_f32 v12, v12, v12
    v_lshlrev_b32 v12, 16, v12
    v_and_b32 v92, 0xffff0000, v161
    v_mul_f32 v92, v92, v103
    v_cvt_pk_bf16_f32 v92, v92, v92
    v_lshlrev_b32 v92, 16, v92
    v_add_f32 v13, v13, v92
    v_cvt_pk_bf16_f32 v13, v13, v13
    v_lshlrev_b32 v13, 16, v13
    v_cvt_pk_bf16_f32 v141, v12, v13
    v_lshlrev_b32 v92, 16, v162
    v_mul_f32 v92, v92, v104
    v_cvt_pk_bf16_f32 v92, v92, v92
    v_lshlrev_b32 v92, 16, v92
    v_add_f32 v14, v14, v92
    v_cvt_pk_bf16_f32 v14, v14, v14
    v_lshlrev_b32 v14, 16, v14
    v_and_b32 v92, 0xffff0000, v162
    v_mul_f32 v92, v92, v105
    v_cvt_pk_bf16_f32 v92, v92, v92
    v_lshlrev_b32 v92, 16, v92
    v_add_f32 v15, v15, v92
    v_cvt_pk_bf16_f32 v15, v15, v15
    v_lshlrev_b32 v15, 16, v15
    v_cvt_pk_bf16_f32 v142, v14, v15
    v_lshlrev_b32 v92, 16, v163
    v_mul_f32 v92, v92, v106
    v_cvt_pk_bf16_f32 v92, v92, v92
    v_lshlrev_b32 v92, 16, v92
    v_add_f32 v16, v16, v92
    v_cvt_pk_bf16_f32 v16, v16, v16
    v_lshlrev_b32 v16, 16, v16
    v_and_b32 v92, 0xffff0000, v163
    v_mul_f32 v92, v92, v107
    v_cvt_pk_bf16_f32 v92, v92, v92
    v_lshlrev_b32 v92, 16, v92
    v_add_f32 v17, v17, v92
    v_cvt_pk_bf16_f32 v17, v17, v17
    v_lshlrev_b32 v17, 16, v17
    v_cvt_pk_bf16_f32 v143, v16, v17
    v_lshlrev_b32 v92, 16, v164
    v_mul_f32 v92, v92, v108
    v_cvt_pk_bf16_f32 v92, v92, v92
    v_lshlrev_b32 v92, 16, v92
    v_add_f32 v18, v18, v92
    v_cvt_pk_bf16_f32 v18, v18, v18
    v_lshlrev_b32 v18, 16, v18
    v_and_b32 v92, 0xffff0000, v164
    v_mul_f32 v92, v92, v109
    v_cvt_pk_bf16_f32 v92, v92, v92
    v_lshlrev_b32 v92, 16, v92
    v_add_f32 v19, v19, v92
    v_cvt_pk_bf16_f32 v19, v19, v19
    v_lshlrev_b32 v19, 16, v19
    v_cvt_pk_bf16_f32 v144, v18, v19
    v_lshlrev_b32 v92, 16, v165
    v_mul_f32 v92, v92, v110
    v_cvt_pk_bf16_f32 v92, v92, v92
    v_lshlrev_b32 v92, 16, v92
    v_add_f32 v20, v20, v92
    v_cvt_pk_bf16_f32 v20, v20, v20
    v_lshlrev_b32 v20, 16, v20
    v_and_b32 v92, 0xffff0000, v165
    v_mul_f32 v92, v92, v111
    v_cvt_pk_bf16_f32 v92, v92, v92
    v_lshlrev_b32 v92, 16, v92
    v_add_f32 v21, v21, v92
    v_cvt_pk_bf16_f32 v21, v21, v21
    v_lshlrev_b32 v21, 16, v21
    v_cvt_pk_bf16_f32 v145, v20, v21
    v_lshlrev_b32 v92, 16, v166
    v_mul_f32 v92, v92, v112
    v_cvt_pk_bf16_f32 v92, v92, v92
    v_lshlrev_b32 v92, 16, v92
    v_add_f32 v22, v22, v92
    v_cvt_pk_bf16_f32 v22, v22, v22
    v_lshlrev_b32 v22, 16, v22
    v_and_b32 v92, 0xffff0000, v166
    v_mul_f32 v92, v92, v113
    v_cvt_pk_bf16_f32 v92, v92, v92
    v_lshlrev_b32 v92, 16, v92
    v_add_f32 v23, v23, v92
    v_cvt_pk_bf16_f32 v23, v23, v23
    v_lshlrev_b32 v23, 16, v23
    v_cvt_pk_bf16_f32 v146, v22, v23
    v_lshlrev_b32 v92, 16, v167
    v_mul_f32 v92, v92, v114
    v_cvt_pk_bf16_f32 v92, v92, v92
    v_lshlrev_b32 v92, 16, v92
    v_add_f32 v24, v24, v92
    v_cvt_pk_bf16_f32 v24, v24, v24
    v_lshlrev_b32 v24, 16, v24
    v_and_b32 v92, 0xffff0000, v167
    v_mul_f32 v92, v92, v115
    v_cvt_pk_bf16_f32 v92, v92, v92
    v_lshlrev_b32 v92, 16, v92
    v_add_f32 v25, v25, v92
    v_cvt_pk_bf16_f32 v25, v25, v25
    v_lshlrev_b32 v25, 16, v25
    v_cvt_pk_bf16_f32 v147, v24, v25
    v_lshlrev_b32 v92, 16, v168
    v_mul_f32 v92, v92, v116
    v_cvt_pk_bf16_f32 v92, v92, v92
    v_lshlrev_b32 v92, 16, v92
    v_add_f32 v26, v26, v92
    v_cvt_pk_bf16_f32 v26, v26, v26
    v_lshlrev_b32 v26, 16, v26
    v_and_b32 v92, 0xffff0000, v168
    v_mul_f32 v92, v92, v117
    v_cvt_pk_bf16_f32 v92, v92, v92
    v_lshlrev_b32 v92, 16, v92
    v_add_f32 v27, v27, v92
    v_cvt_pk_bf16_f32 v27, v27, v27
    v_lshlrev_b32 v27, 16, v27
    v_cvt_pk_bf16_f32 v148, v26, v27
    v_lshlrev_b32 v92, 16, v169
    v_mul_f32 v92, v92, v118
    v_cvt_pk_bf16_f32 v92, v92, v92
    v_lshlrev_b32 v92, 16, v92
    v_add_f32 v28, v28, v92
    v_cvt_pk_bf16_f32 v28, v28, v28
    v_lshlrev_b32 v28, 16, v28
    v_and_b32 v92, 0xffff0000, v169
    v_mul_f32 v92, v92, v119
    v_cvt_pk_bf16_f32 v92, v92, v92
    v_lshlrev_b32 v92, 16, v92
    v_add_f32 v29, v29, v92
    v_cvt_pk_bf16_f32 v29, v29, v29
    v_lshlrev_b32 v29, 16, v29
    v_cvt_pk_bf16_f32 v149, v28, v29
    v_lshlrev_b32 v92, 16, v170
    v_mul_f32 v92, v92, v120
    v_cvt_pk_bf16_f32 v92, v92, v92
    v_lshlrev_b32 v92, 16, v92
    v_add_f32 v30, v30, v92
    v_cvt_pk_bf16_f32 v30, v30, v30
    v_lshlrev_b32 v30, 16, v30
    v_and_b32 v92, 0xffff0000, v170
    v_mul_f32 v92, v92, v121
    v_cvt_pk_bf16_f32 v92, v92, v92
    v_lshlrev_b32 v92, 16, v92
    v_add_f32 v31, v31, v92
    v_cvt_pk_bf16_f32 v31, v31, v31
    v_lshlrev_b32 v31, 16, v31
    v_cvt_pk_bf16_f32 v150, v30, v31
    v_lshlrev_b32 v92, 16, v171
    v_mul_f32 v92, v92, v122
    v_cvt_pk_bf16_f32 v92, v92, v92
    v_lshlrev_b32 v92, 16, v92
    v_add_f32 v32, v32, v92
    v_cvt_pk_bf16_f32 v32, v32, v32
    v_lshlrev_b32 v32, 16, v32
    v_and_b32 v92, 0xffff0000, v171
    v_mul_f32 v92, v92, v123
    v_cvt_pk_bf16_f32 v92, v92, v92
    v_lshlrev_b32 v92, 16, v92
    v_add_f32 v33, v33, v92
    v_cvt_pk_bf16_f32 v33, v33, v33
    v_lshlrev_b32 v33, 16, v33
    v_cvt_pk_bf16_f32 v151, v32, v33
    v_lshlrev_b32 v92, 16, v172
    v_mul_f32 v92, v92, v124
    v_cvt_pk_bf16_f32 v92, v92, v92
    v_lshlrev_b32 v92, 16, v92
    v_add_f32 v34, v34, v92
    v_cvt_pk_bf16_f32 v34, v34, v34
    v_lshlrev_b32 v34, 16, v34
    v_and_b32 v92, 0xffff0000, v172
    v_mul_f32 v92, v92, v125
    v_cvt_pk_bf16_f32 v92, v92, v92
    v_lshlrev_b32 v92, 16, v92
    v_add_f32 v35, v35, v92
    v_cvt_pk_bf16_f32 v35, v35, v35
    v_lshlrev_b32 v35, 16, v35
    v_cvt_pk_bf16_f32 v152, v34, v35
    v_lshlrev_b32 v92, 16, v173
    v_mul_f32 v92, v92, v126
    v_cvt_pk_bf16_f32 v92, v92, v92
    v_lshlrev_b32 v92, 16, v92
    v_add_f32 v36, v36, v92
    v_cvt_pk_bf16_f32 v36, v36, v36
    v_lshlrev_b32 v36, 16, v36
    v_and_b32 v92, 0xffff0000, v173
    v_mul_f32 v92, v92, v127
    v_cvt_pk_bf16_f32 v92, v92, v92
    v_lshlrev_b32 v92, 16, v92
    v_add_f32 v37, v37, v92
    v_cvt_pk_bf16_f32 v37, v37, v37
    v_lshlrev_b32 v37, 16, v37
    v_cvt_pk_bf16_f32 v153, v36, v37
    v_lshlrev_b32 v92, 16, v174
    v_mul_f32 v92, v92, v128
    v_cvt_pk_bf16_f32 v92, v92, v92
    v_lshlrev_b32 v92, 16, v92
    v_add_f32 v38, v38, v92
    v_cvt_pk_bf16_f32 v38, v38, v38
    v_lshlrev_b32 v38, 16, v38
    v_and_b32 v92, 0xffff0000, v174
    v_mul_f32 v92, v92, v129
    v_cvt_pk_bf16_f32 v92, v92, v92
    v_lshlrev_b32 v92, 16, v92
    v_add_f32 v39, v39, v92
    v_cvt_pk_bf16_f32 v39, v39, v39
    v_lshlrev_b32 v39, 16, v39
    v_cvt_pk_bf16_f32 v154, v38, v39
    v_lshlrev_b32 v92, 16, v175
    v_mul_f32 v92, v92, v130
    v_cvt_pk_bf16_f32 v92, v92, v92
    v_lshlrev_b32 v92, 16, v92
    v_add_f32 v40, v40, v92
    v_cvt_pk_bf16_f32 v40, v40, v40
    v_lshlrev_b32 v40, 16, v40
    v_and_b32 v92, 0xffff0000, v175
    v_mul_f32 v92, v92, v131
    v_cvt_pk_bf16_f32 v92, v92, v92
    v_lshlrev_b32 v92, 16, v92
    v_add_f32 v41, v41, v92
    v_cvt_pk_bf16_f32 v41, v41, v41
    v_lshlrev_b32 v41, 16, v41
    v_cvt_pk_bf16_f32 v155, v40, v41
    v_lshlrev_b32 v92, 16, v176
    v_mul_f32 v92, v92, v132
    v_cvt_pk_bf16_f32 v92, v92, v92
    v_lshlrev_b32 v92, 16, v92
    v_add_f32 v42, v42, v92
    v_cvt_pk_bf16_f32 v42, v42, v42
    v_lshlrev_b32 v42, 16, v42
    v_and_b32 v92, 0xffff0000, v176
    v_mul_f32 v92, v92, v133
    v_cvt_pk_bf16_f32 v92, v92, v92
    v_lshlrev_b32 v92, 16, v92
    v_add_f32 v43, v43, v92
    v_cvt_pk_bf16_f32 v43, v43, v43
    v_lshlrev_b32 v43, 16, v43
    v_cvt_pk_bf16_f32 v156, v42, v43
    v_lshlrev_b32 v92, 16, v177
    v_mul_f32 v92, v92, v134
    v_cvt_pk_bf16_f32 v92, v92, v92
    v_lshlrev_b32 v92, 16, v92
    v_add_f32 v44, v44, v92
    v_cvt_pk_bf16_f32 v44, v44, v44
    v_lshlrev_b32 v44, 16, v44
    v_and_b32 v92, 0xffff0000, v177
    v_mul_f32 v92, v92, v135
    v_cvt_pk_bf16_f32 v92, v92, v92
    v_lshlrev_b32 v92, 16, v92
    v_add_f32 v45, v45, v92
    v_cvt_pk_bf16_f32 v45, v45, v45
    v_lshlrev_b32 v45, 16, v45
    v_cvt_pk_bf16_f32 v157, v44, v45
    v_lshlrev_b32 v92, 16, v178
    v_mul_f32 v92, v92, v136
    v_cvt_pk_bf16_f32 v92, v92, v92
    v_lshlrev_b32 v92, 16, v92
    v_add_f32 v46, v46, v92
    v_cvt_pk_bf16_f32 v46, v46, v46
    v_lshlrev_b32 v46, 16, v46
    v_and_b32 v92, 0xffff0000, v178
    v_mul_f32 v92, v92, v137
    v_cvt_pk_bf16_f32 v92, v92, v92
    v_lshlrev_b32 v92, 16, v92
    v_add_f32 v47, v47, v92
    v_cvt_pk_bf16_f32 v47, v47, v47
    v_lshlrev_b32 v47, 16, v47
    v_cvt_pk_bf16_f32 v158, v46, v47
    v_lshlrev_b32 v92, 16, v179
    v_mul_f32 v92, v92, v138
    v_cvt_pk_bf16_f32 v92, v92, v92
    v_lshlrev_b32 v92, 16, v92
    v_add_f32 v48, v48, v92
    v_cvt_pk_bf16_f32 v48, v48, v48
    v_lshlrev_b32 v48, 16, v48
    v_and_b32 v92, 0xffff0000, v179
    v_mul_f32 v92, v92, v139
    v_cvt_pk_bf16_f32 v92, v92, v92
    v_lshlrev_b32 v92, 16, v92
    v_add_f32 v49, v49, v92
    v_cvt_pk_bf16_f32 v49, v49, v49
    v_lshlrev_b32 v49, 16, v49
    v_cvt_pk_bf16_f32 v159, v48, v49
    buffer_store_dwordx4 v[140:143], v3, s[16:19], 0 offen offset:0
    buffer_store_dwordx4 v[144:147], v3, s[16:19], 0 offen offset:256
    buffer_store_dwordx4 v[148:151], v3, s[16:19], 0 offen offset:512
    buffer_store_dwordx4 v[152:155], v3, s[16:19], 0 offen offset:768
    buffer_store_dwordx4 v[156:159], v3, s[16:19], 0 offen offset:1024
    v_mov_b32 v90, v10
    v_add_f32 v90, v90, v11
    v_add_f32 v90, v90, v12
    v_add_f32 v90, v90, v13
    v_add_f32 v90, v90, v14
    v_add_f32 v90, v90, v15
    v_add_f32 v90, v90, v16
    v_add_f32 v90, v90, v17
    v_add_f32 v90, v90, v18
    v_add_f32 v90, v90, v19
    v_add_f32 v90, v90, v20
    v_add_f32 v90, v90, v21
    v_add_f32 v90, v90, v22
    v_add_f32 v90, v90, v23
    v_add_f32 v90, v90, v24
    v_add_f32 v90, v90, v25
    v_add_f32 v90, v90, v26
    v_add_f32 v90, v90, v27
    v_add_f32 v90, v90, v28
    v_add_f32 v90, v90, v29
    v_add_f32 v90, v90, v30
    v_add_f32 v90, v90, v31
    v_add_f32 v90, v90, v32
    v_add_f32 v90, v90, v33
    v_add_f32 v90, v90, v34
    v_add_f32 v90, v90, v35
    v_add_f32 v90, v90, v36
    v_add_f32 v90, v90, v37
    v_add_f32 v90, v90, v38
    v_add_f32 v90, v90, v39
    v_add_f32 v90, v90, v40
    v_add_f32 v90, v90, v41
    v_add_f32 v90, v90, v42
    v_add_f32 v90, v90, v43
    v_add_f32 v90, v90, v44
    v_add_f32 v90, v90, v45
    v_add_f32 v90, v90, v46
    v_add_f32 v90, v90, v47
    v_add_f32 v90, v90, v48
    v_add_f32 v90, v90, v49
    s_nop 1
    v_add_f32_dpp v90, v90, v90 row_ror:8 row_mask:0xf bank_mask:0xf
    s_nop 1
    v_add_f32_dpp v90, v90, v90 row_ror:4 row_mask:0xf bank_mask:0xf
    s_nop 1
    v_add_f32_dpp v90, v90, v90 row_ror:2 row_mask:0xf bank_mask:0xf
    s_nop 1
    v_add_f32_dpp v90, v90, v90 row_ror:1 row_mask:0xf bank_mask:0xf
    v_mul_f32 v90, 0.0015625, v90
    v_mov_b32 v91, 0
    v_sub_f32 v92, v10, v90
    v_fmac_f32 v91, v92, v92
    v_sub_f32 v92, v11, v90
    v_fmac_f32 v91, v92, v92
    v_sub_f32 v92, v12, v90
    v_fmac_f32 v91, v92, v92
    v_sub_f32 v92, v13, v90
    v_fmac_f32 v91, v92, v92
    v_sub_f32 v92, v14, v90
    v_fmac_f32 v91, v92, v92
    v_sub_f32 v92, v15, v90
    v_fmac_f32 v91, v92, v92
    v_sub_f32 v92, v16, v90
    v_fmac_f32 v91, v92, v92
    v_sub_f32 v92, v17, v90
    v_fmac_f32 v91, v92, v92
    v_sub_f32 v92, v18, v90
    v_fmac_f32 v91, v92, v92
    v_sub_f32 v92, v19, v90
    v_fmac_f32 v91, v92, v92
    v_sub_f32 v92, v20, v90
    v_fmac_f32 v91, v92, v92
    v_sub_f32 v92, v21, v90
    v_fmac_f32 v91, v92, v92
    v_sub_f32 v92, v22, v90
    v_fmac_f32 v91, v92, v92
    v_sub_f32 v92, v23, v90
    v_fmac_f32 v91, v92, v92
    v_sub_f32 v92, v24, v90
    v_fmac_f32 v91, v92, v92
    v_sub_f32 v92, v25, v90
    v_fmac_f32 v91, v92, v92
    v_sub_f32 v92, v26, v90
    v_fmac_f32 v91, v92, v92
    v_sub_f32 v92, v27, v90
    v_fmac_f32 v91, v92, v92
    v_sub_f32 v92, v28, v90
    v_fmac_f32 v91, v92, v92
    v_sub_f32 v92, v29, v90
    v_fmac_f32 v91, v92, v92
    v_sub_f32 v92, v30, v90
    v_fmac_f32 v91, v92, v92
    v_sub_f32 v92, v31, v90
    v_fmac_f32 v91, v92, v92
    v_sub_f32 v92, v32, v90
    v_fmac_f32 v91, v92, v92
    v_sub_f32 v92, v33, v90
    v_fmac_f32 v91, v92, v92
    v_sub_f32 v92, v34, v90
    v_fmac_f32 v91, v92, v92
    v_sub_f32 v92, v35, v90
    v_fmac_f32 v91, v92, v92
    v_sub_f32 v92, v36, v90
    v_fmac_f32 v91, v92, v92
    v_sub_f32 v92, v37, v90
    v_fmac_f32 v91, v92, v92
    v_sub_f32 v92, v38, v90
    v_fmac_f32 v91, v92, v92
    v_sub_f32 v92, v39, v90
    v_fmac_f32 v91, v92, v92
    v_sub_f32 v92, v40, v90
    v_fmac_f32 v91, v92, v92
    v_sub_f32 v92, v41, v90
    v_fmac_f32 v91, v92, v92
    v_sub_f32 v92, v42, v90
    v_fmac_f32 v91, v92, v92
    v_sub_f32 v92, v43, v90
    v_fmac_f32 v91, v92, v92
    v_sub_f32 v92, v44, v90
    v_fmac_f32 v91, v92, v92
    v_sub_f32 v92, v45, v90
    v_fmac_f32 v91, v92, v92
    v_sub_f32 v92, v46, v90
    v_fmac_f32 v91, v92, v92
    v_sub_f32 v92, v47, v90
    v_fmac_f32 v91, v92, v92
    v_sub_f32 v92, v48, v90
    v_fmac_f32 v91, v92, v92
    v_sub_f32 v92, v49, v90
    v_fmac_f32 v91, v92, v92
    s_nop 1
    v_add_f32_dpp v91, v91, v91 row_ror:8 row_mask:0xf bank_mask:0xf
    s_nop 1
    v_add_f32_dpp v91, v91, v91 row_ror:4 row_mask:0xf bank_mask:0xf
    s_nop 1
    v_add_f32_dpp v91, v91, v91 row_ror:2 row_mask:0xf bank_mask:0xf
    s_nop 1
    v_add_f32_dpp v91, v91, v91 row_ror:1 row_mask:0xf bank_mask:0xf
    v_mul_f32 v91, 0.0015625, v91
    v_cvt_pk_bf16_f32 v91, v91, v91
    v_lshlrev_b32 v91, 16, v91
    v_add_f32 v91, 0x3727c5ac, v91
    v_cvt_pk_bf16_f32 v91, v91, v91
    v_lshlrev_b32 v91, 16, v91
    v_sqrt_f32 v91, v91
    s_nop 0
    v_cvt_pk_bf16_f32 v91, v91, v91
    v_lshlrev_b32 v91, 16, v91
    v_rcp_f32 v91, v91
    v_cvt_pk_bf16_f32 v90, v90, v90
    v_lshlrev_b32 v90, 16, v90
    v_sub_f32 v100, v10, v90
    v_cvt_pk_bf16_f32 v100, v100, v100
    v_lshlrev_b32 v100, 16, v100
    v_mul_f32 v100, v100, v91
    v_cvt_pk_bf16_f32 v100, v100, v100
    v_lshlrev_b32 v100, 16, v100
    v_sub_f32 v101, v11, v90
    v_cvt_pk_bf16_f32 v101, v101, v101
    v_lshlrev_b32 v101, 16, v101
    v_mul_f32 v101, v101, v91
    v_cvt_pk_bf16_f32 v101, v101, v101
    v_lshlrev_b32 v101, 16, v101
    v_sub_f32 v102, v12, v90
    v_cvt_pk_bf16_f32 v102, v102, v102
    v_lshlrev_b32 v102, 16, v102
    v_mul_f32 v102, v102, v91
    v_cvt_pk_bf16_f32 v102, v102, v102
    v_lshlrev_b32 v102, 16, v102
    v_sub_f32 v103, v13, v90
    v_cvt_pk_bf16_f32 v103, v103, v103
    v_lshlrev_b32 v103, 16, v103
    v_mul_f32 v103, v103, v91
    v_cvt_pk_bf16_f32 v103, v103, v103
    v_lshlrev_b32 v103, 16, v103
    v_sub_f32 v104, v14, v90
    v_cvt_pk_bf16_f32 v104, v104, v104
    v_lshlrev_b32 v104, 16, v104
    v_mul_f32 v104, v104, v91
    v_cvt_pk_bf16_f32 v104, v104, v104
    v_lshlrev_b32 v104, 16, v104
    v_sub_f32 v105, v15, v90
    v_cvt_pk_bf16_f32 v105, v105, v105
    v_lshlrev_b32 v105, 16, v105
    v_mul_f32 v105, v105, v91
    v_cvt_pk_bf16_f32 v105, v105, v105
    v_lshlrev_b32 v105, 16, v105
    v_sub_f32 v106, v16, v90
    v_cvt_pk_bf16_f32 v106, v106, v106
    v_lshlrev_b32 v106, 16, v106
    v_mul_f32 v106, v106, v91
    v_cvt_pk_bf16_f32 v106, v106, v106
    v_lshlrev_b32 v106, 16, v106
    v_sub_f32 v107, v17, v90
    v_cvt_pk_bf16_f32 v107, v107, v107
    v_lshlrev_b32 v107, 16, v107
    v_mul_f32 v107, v107, v91
    v_cvt_pk_bf16_f32 v107, v107, v107
    v_lshlrev_b32 v107, 16, v107
    v_sub_f32 v108, v18, v90
    v_cvt_pk_bf16_f32 v108, v108, v108
    v_lshlrev_b32 v108, 16, v108
    v_mul_f32 v108, v108, v91
    v_cvt_pk_bf16_f32 v108, v108, v108
    v_lshlrev_b32 v108, 16, v108
    v_sub_f32 v109, v19, v90
    v_cvt_pk_bf16_f32 v109, v109, v109
    v_lshlrev_b32 v109, 16, v109
    v_mul_f32 v109, v109, v91
    v_cvt_pk_bf16_f32 v109, v109, v109
    v_lshlrev_b32 v109, 16, v109
    v_sub_f32 v110, v20, v90
    v_cvt_pk_bf16_f32 v110, v110, v110
    v_lshlrev_b32 v110, 16, v110
    v_mul_f32 v110, v110, v91
    v_cvt_pk_bf16_f32 v110, v110, v110
    v_lshlrev_b32 v110, 16, v110
    v_sub_f32 v111, v21, v90
    v_cvt_pk_bf16_f32 v111, v111, v111
    v_lshlrev_b32 v111, 16, v111
    v_mul_f32 v111, v111, v91
    v_cvt_pk_bf16_f32 v111, v111, v111
    v_lshlrev_b32 v111, 16, v111
    v_sub_f32 v112, v22, v90
    v_cvt_pk_bf16_f32 v112, v112, v112
    v_lshlrev_b32 v112, 16, v112
    v_mul_f32 v112, v112, v91
    v_cvt_pk_bf16_f32 v112, v112, v112
    v_lshlrev_b32 v112, 16, v112
    v_sub_f32 v113, v23, v90
    v_cvt_pk_bf16_f32 v113, v113, v113
    v_lshlrev_b32 v113, 16, v113
    v_mul_f32 v113, v113, v91
    v_cvt_pk_bf16_f32 v113, v113, v113
    v_lshlrev_b32 v113, 16, v113
    v_sub_f32 v114, v24, v90
    v_cvt_pk_bf16_f32 v114, v114, v114
    v_lshlrev_b32 v114, 16, v114
    v_mul_f32 v114, v114, v91
    v_cvt_pk_bf16_f32 v114, v114, v114
    v_lshlrev_b32 v114, 16, v114
    v_sub_f32 v115, v25, v90
    v_cvt_pk_bf16_f32 v115, v115, v115
    v_lshlrev_b32 v115, 16, v115
    v_mul_f32 v115, v115, v91
    v_cvt_pk_bf16_f32 v115, v115, v115
    v_lshlrev_b32 v115, 16, v115
    v_sub_f32 v116, v26, v90
    v_cvt_pk_bf16_f32 v116, v116, v116
    v_lshlrev_b32 v116, 16, v116
    v_mul_f32 v116, v116, v91
    v_cvt_pk_bf16_f32 v116, v116, v116
    v_lshlrev_b32 v116, 16, v116
    v_sub_f32 v117, v27, v90
    v_cvt_pk_bf16_f32 v117, v117, v117
    v_lshlrev_b32 v117, 16, v117
    v_mul_f32 v117, v117, v91
    v_cvt_pk_bf16_f32 v117, v117, v117
    v_lshlrev_b32 v117, 16, v117
    v_sub_f32 v118, v28, v90
    v_cvt_pk_bf16_f32 v118, v118, v118
    v_lshlrev_b32 v118, 16, v118
    v_mul_f32 v118, v118, v91
    v_cvt_pk_bf16_f32 v118, v118, v118
    v_lshlrev_b32 v118, 16, v118
    v_sub_f32 v119, v29, v90
    v_cvt_pk_bf16_f32 v119, v119, v119
    v_lshlrev_b32 v119, 16, v119
    v_mul_f32 v119, v119, v91
    v_cvt_pk_bf16_f32 v119, v119, v119
    v_lshlrev_b32 v119, 16, v119
    v_sub_f32 v120, v30, v90
    v_cvt_pk_bf16_f32 v120, v120, v120
    v_lshlrev_b32 v120, 16, v120
    v_mul_f32 v120, v120, v91
    v_cvt_pk_bf16_f32 v120, v120, v120
    v_lshlrev_b32 v120, 16, v120
    v_sub_f32 v121, v31, v90
    v_cvt_pk_bf16_f32 v121, v121, v121
    v_lshlrev_b32 v121, 16, v121
    v_mul_f32 v121, v121, v91
    v_cvt_pk_bf16_f32 v121, v121, v121
    v_lshlrev_b32 v121, 16, v121
    v_sub_f32 v122, v32, v90
    v_cvt_pk_bf16_f32 v122, v122, v122
    v_lshlrev_b32 v122, 16, v122
    v_mul_f32 v122, v122, v91
    v_cvt_pk_bf16_f32 v122, v122, v122
    v_lshlrev_b32 v122, 16, v122
    v_sub_f32 v123, v33, v90
    v_cvt_pk_bf16_f32 v123, v123, v123
    v_lshlrev_b32 v123, 16, v123
    v_mul_f32 v123, v123, v91
    v_cvt_pk_bf16_f32 v123, v123, v123
    v_lshlrev_b32 v123, 16, v123
    v_sub_f32 v124, v34, v90
    v_cvt_pk_bf16_f32 v124, v124, v124
    v_lshlrev_b32 v124, 16, v124
    v_mul_f32 v124, v124, v91
    v_cvt_pk_bf16_f32 v124, v124, v124
    v_lshlrev_b32 v124, 16, v124
    v_sub_f32 v125, v35, v90
    v_cvt_pk_bf16_f32 v125, v125, v125
    v_lshlrev_b32 v125, 16, v125
    v_mul_f32 v125, v125, v91
    v_cvt_pk_bf16_f32 v125, v125, v125
    v_lshlrev_b32 v125, 16, v125
    v_sub_f32 v126, v36, v90
    v_cvt_pk_bf16_f32 v126, v126, v126
    v_lshlrev_b32 v126, 16, v126
    v_mul_f32 v126, v126, v91
    v_cvt_pk_bf16_f32 v126, v126, v126
    v_lshlrev_b32 v126, 16, v126
    v_sub_f32 v127, v37, v90
    v_cvt_pk_bf16_f32 v127, v127, v127
    v_lshlrev_b32 v127, 16, v127
    v_mul_f32 v127, v127, v91
    v_cvt_pk_bf16_f32 v127, v127, v127
    v_lshlrev_b32 v127, 16, v127
    v_sub_f32 v128, v38, v90
    v_cvt_pk_bf16_f32 v128, v128, v128
    v_lshlrev_b32 v128, 16, v128
    v_mul_f32 v128, v128, v91
    v_cvt_pk_bf16_f32 v128, v128, v128
    v_lshlrev_b32 v128, 16, v128
    v_sub_f32 v129, v39, v90
    v_cvt_pk_bf16_f32 v129, v129, v129
    v_lshlrev_b32 v129, 16, v129
    v_mul_f32 v129, v129, v91
    v_cvt_pk_bf16_f32 v129, v129, v129
    v_lshlrev_b32 v129, 16, v129
    v_sub_f32 v130, v40, v90
    v_cvt_pk_bf16_f32 v130, v130, v130
    v_lshlrev_b32 v130, 16, v130
    v_mul_f32 v130, v130, v91
    v_cvt_pk_bf16_f32 v130, v130, v130
    v_lshlrev_b32 v130, 16, v130
    v_sub_f32 v131, v41, v90
    v_cvt_pk_bf16_f32 v131, v131, v131
    v_lshlrev_b32 v131, 16, v131
    v_mul_f32 v131, v131, v91
    v_cvt_pk_bf16_f32 v131, v131, v131
    v_lshlrev_b32 v131, 16, v131
    v_sub_f32 v132, v42, v90
    v_cvt_pk_bf16_f32 v132, v132, v132
    v_lshlrev_b32 v132, 16, v132
    v_mul_f32 v132, v132, v91
    v_cvt_pk_bf16_f32 v132, v132, v132
    v_lshlrev_b32 v132, 16, v132
    v_sub_f32 v133, v43, v90
    v_cvt_pk_bf16_f32 v133, v133, v133
    v_lshlrev_b32 v133, 16, v133
    v_mul_f32 v133, v133, v91
    v_cvt_pk_bf16_f32 v133, v133, v133
    v_lshlrev_b32 v133, 16, v133
    v_sub_f32 v134, v44, v90
    v_cvt_pk_bf16_f32 v134, v134, v134
    v_lshlrev_b32 v134, 16, v134
    v_mul_f32 v134, v134, v91
    v_cvt_pk_bf16_f32 v134, v134, v134
    v_lshlrev_b32 v134, 16, v134
    v_sub_f32 v135, v45, v90
    v_cvt_pk_bf16_f32 v135, v135, v135
    v_lshlrev_b32 v135, 16, v135
    v_mul_f32 v135, v135, v91
    v_cvt_pk_bf16_f32 v135, v135, v135
    v_lshlrev_b32 v135, 16, v135
    v_sub_f32 v136, v46, v90
    v_cvt_pk_bf16_f32 v136, v136, v136
    v_lshlrev_b32 v136, 16, v136
    v_mul_f32 v136, v136, v91
    v_cvt_pk_bf16_f32 v136, v136, v136
    v_lshlrev_b32 v136, 16, v136
    v_sub_f32 v137, v47, v90
    v_cvt_pk_bf16_f32 v137, v137, v137
    v_lshlrev_b32 v137, 16, v137
    v_mul_f32 v137, v137, v91
    v_cvt_pk_bf16_f32 v137, v137, v137
    v_lshlrev_b32 v137, 16, v137
    v_sub_f32 v138, v48, v90
    v_cvt_pk_bf16_f32 v138, v138, v138
    v_lshlrev_b32 v138, 16, v138
    v_mul_f32 v138, v138, v91
    v_cvt_pk_bf16_f32 v138, v138, v138
    v_lshlrev_b32 v138, 16, v138
    v_sub_f32 v139, v49, v90
    v_cvt_pk_bf16_f32 v139, v139, v139
    v_lshlrev_b32 v139, 16, v139
    v_mul_f32 v139, v139, v91
    v_cvt_pk_bf16_f32 v139, v139, v139
    v_lshlrev_b32 v139, 16, v139
    v_cvt_pk_bf16_f32 v160, v100, v101
    v_cvt_pk_bf16_f32 v161, v102, v103
    v_cvt_pk_bf16_f32 v162, v104, v105
    v_cvt_pk_bf16_f32 v163, v106, v107
    v_cvt_pk_bf16_f32 v164, v108, v109
    v_cvt_pk_bf16_f32 v165, v110, v111
    v_cvt_pk_bf16_f32 v166, v112, v113
    v_cvt_pk_bf16_f32 v167, v114, v115
    v_cvt_pk_bf16_f32 v168, v116, v117
    v_cvt_pk_bf16_f32 v169, v118, v119
    v_cvt_pk_bf16_f32 v170, v120, v121
    v_cvt_pk_bf16_f32 v171, v122, v123
    v_cvt_pk_bf16_f32 v172, v124, v125
    v_cvt_pk_bf16_f32 v173, v126, v127
    v_cvt_pk_bf16_f32 v174, v128, v129
    v_cvt_pk_bf16_f32 v175, v130, v131
    v_cvt_pk_bf16_f32 v176, v132, v133
    v_cvt_pk_bf16_f32 v177, v134, v135
    v_cvt_pk_bf16_f32 v178, v136, v137
    v_cvt_pk_bf16_f32 v179, v138, v139
    v_lshrrev_b32 v4, 5, v1
    v_mul_u32_u24 v4, 42240, v4
    v_and_b32 v5, 31, v1
    v_lshl_add_u32 v4, v5, 4, v4
    v_lshl_add_u32 v4, v2, 9, v4
    buffer_store_dwordx4 v[160:163], v4, s[20:23], 0 offen
    v_add_u32 v4, 8192, v4
    buffer_store_dwordx4 v[164:167], v4, s[20:23], 0 offen
    v_add_u32 v4, 8192, v4
    buffer_store_dwordx4 v[168:171], v4, s[20:23], 0 offen
    v_add_u32 v4, 8192, v4
    buffer_store_dwordx4 v[172:175], v4, s[20:23], 0 offen
    v_add_u32 v4, 8192, v4
    buffer_store_dwordx4 v[176:179], v4, s[20:23], 0 offen
    v_add_u32 v4, 8192, v4
k1_kernel_end:
    s_endpgm
.globl k2_kernel
.p2align 8
.type k2_kernel,@function
k2_kernel:
    s_cmp_ge_u32 s2, 216
    s_cbranch_scc1 k2_kernel_end
    s_load_dwordx2 s[4:5], s[0:1], 96
    s_load_dwordx2 s[6:7], s[0:1], 80
    s_lshr_b32 s3, s2, 3
    s_mul_hi_u32 s24, s3, 159072863
    s_mul_i32 s25, s24, 27
    s_sub_u32 s25, s3, s25
    s_and_b32 s3, s2, 7
    s_lshl_b32 s3, s3, 2
    s_add_u32 s24, s24, s3
    v_and_b32 v9, 63, v0
    v_lshlrev_b32 v9, 4, v9
    v_lshrrev_b32 v8, 6, v0
    s_nop 1
    v_readfirstlane_b32 s26, v8
    s_and_b32 s3, s2, 7
    s_mul_i32 s3, s3, 27
    s_lshr_b32 s24, s2, 3
    s_add_u32 s3, s3, s24
    s_lshr_b32 s25, s3, 3
    s_and_b32 s24, s3, 7
    s_lshl_b32 s24, s24, 2
    s_add_u32 s24, s24, s26
    s_waitcnt lgkmcnt(0)
    s_add_u32 s8, s4, 19922944
    s_addc_u32 s9, s5, 0
    s_and_b32 s9, s9, 0xffff
    s_mov_b32 s10, 2703360
    s_mov_b32 s11, 0x00020000
    s_add_u32 s12, s4, 0
    s_addc_u32 s13, s5, 0
    s_and_b32 s13, s13, 0xffff
    s_mov_b32 s14, 4561920
    s_mov_b32 s15, 0x00020000
    s_add_u32 s16, s4, 23068672
    s_addc_u32 s17, s5, 0
    s_and_b32 s17, s17, 0xffff
    s_mov_b32 s18, 7159808
    s_mov_b32 s19, 0x00020000
    s_lshl_b32 s27, s24, 1
    s_add_u32 s27, s27, 0
    s_mul_i32 s27, s27, 42240
    v_add_u32 v1, s27, v9
    s_lshl_b32 s27, s24, 1
    s_add_u32 s27, s27, 1
    s_mul_i32 s27, s27, 42240
    v_add_u32 v2, s27, v9
    s_mul_i32 s27, s25, 4
    s_add_u32 s27, s27, 0
    s_mul_i32 s27, s27, 42240
    v_add_u32 v3, s27, v9
    s_mul_i32 s27, s25, 4
    s_add_u32 s27, s27, 1
    s_mul_i32 s27, s27, 42240
    v_add_u32 v4, s27, v9
    s_mul_i32 s27, s25, 4
    s_add_u32 s27, s27, 2
    s_mul_i32 s27, s27, 42240
    v_add_u32 v5, s27, v9
    s_mul_i32 s27, s25, 4
    s_add_u32 s27, s27, 3
    s_mul_i32 s27, s27, 42240
    v_add_u32 v6, s27, v9
    v_mov_b32 v80, 0
    v_mov_b32 v81, 0
    v_mov_b32 v82, 0
    v_mov_b32 v83, 0
    v_mov_b32 v84, 0
    v_mov_b32 v85, 0
    v_mov_b32 v86, 0
    v_mov_b32 v87, 0
    v_mov_b32 v88, 0
    v_mov_b32 v89, 0
    v_mov_b32 v90, 0
    v_mov_b32 v91, 0
    v_mov_b32 v92, 0
    v_mov_b32 v93, 0
    v_mov_b32 v94, 0
    v_mov_b32 v95, 0
    v_mov_b32 v96, 0
    v_mov_b32 v97, 0
    v_mov_b32 v98, 0
    v_mov_b32 v99, 0
    v_mov_b32 v100, 0
    v_mov_b32 v101, 0
    v_mov_b32 v102, 0
    v_mov_b32 v103, 0
    v_mov_b32 v104, 0
    v_mov_b32 v105, 0
    v_mov_b32 v106, 0
    v_mov_b32 v107, 0
    v_mov_b32 v108, 0
    v_mov_b32 v109, 0
    v_mov_b32 v110, 0
    v_mov_b32 v111, 0
    v_mov_b32 v112, 0
    v_mov_b32 v113, 0
    v_mov_b32 v114, 0
    v_mov_b32 v115, 0
    v_mov_b32 v116, 0
    v_mov_b32 v117, 0
    v_mov_b32 v118, 0
    v_mov_b32 v119, 0
    v_mov_b32 v120, 0
    v_mov_b32 v121, 0
    v_mov_b32 v122, 0
    v_mov_b32 v123, 0
    v_mov_b32 v124, 0
    v_mov_b32 v125, 0
    v_mov_b32 v126, 0
    v_mov_b32 v127, 0
    v_mov_b32 v128, 0
    v_mov_b32 v129, 0
    v_mov_b32 v130, 0
    v_mov_b32 v131, 0
    v_mov_b32 v132, 0
    v_mov_b32 v133, 0
    v_mov_b32 v134, 0
    v_mov_b32 v135, 0
    v_mov_b32 v136, 0
    v_mov_b32 v137, 0
    v_mov_b32 v138, 0
    v_mov_b32 v139, 0
    v_mov_b32 v140, 0
    v_mov_b32 v141, 0
    v_mov_b32 v142, 0
    v_mov_b32 v143, 0
    v_mov_b32 v144, 0
    v_mov_b32 v145, 0
    v_mov_b32 v146, 0
    v_mov_b32 v147, 0
    v_mov_b32 v148, 0
    v_mov_b32 v149, 0
    v_mov_b32 v150, 0
    v_mov_b32 v151, 0
    v_mov_b32 v152, 0
    v_mov_b32 v153, 0
    v_mov_b32 v154, 0
    v_mov_b32 v155, 0
    v_mov_b32 v156, 0
    v_mov_b32 v157, 0
    v_mov_b32 v158, 0
    v_mov_b32 v159, 0
    v_mov_b32 v160, 0
    v_mov_b32 v161, 0
    v_mov_b32 v162, 0
    v_mov_b32 v163, 0
    v_mov_b32 v164, 0
    v_mov_b32 v165, 0
    v_mov_b32 v166, 0
    v_mov_b32 v167, 0
    v_mov_b32 v168, 0
    v_mov_b32 v169, 0
    v_mov_b32 v170, 0
    v_mov_b32 v171, 0
    v_mov_b32 v172, 0
    v_mov_b32 v173, 0
    v_mov_b32 v174, 0
    v_mov_b32 v175, 0
    v_mov_b32 v176, 0
    v_mov_b32 v177, 0
    v_mov_b32 v178, 0
    v_mov_b32 v179, 0
    v_mov_b32 v180, 0
    v_mov_b32 v181, 0
    v_mov_b32 v182, 0
    v_mov_b32 v183, 0
    v_mov_b32 v184, 0
    v_mov_b32 v185, 0
    v_mov_b32 v186, 0
    v_mov_b32 v187, 0
    v_mov_b32 v188, 0
    v_mov_b32 v189, 0
    v_mov_b32 v190, 0
    v_mov_b32 v191, 0
    v_mov_b32 v192, 0
    v_mov_b32 v193, 0
    v_mov_b32 v194, 0
    v_mov_b32 v195, 0
    v_mov_b32 v196, 0
    v_mov_b32 v197, 0
    v_mov_b32 v198, 0
    v_mov_b32 v199, 0
    v_mov_b32 v200, 0
    v_mov_b32 v201, 0
    v_mov_b32 v202, 0
    v_mov_b32 v203, 0
    v_mov_b32 v204, 0
    v_mov_b32 v205, 0
    v_mov_b32 v206, 0
    v_mov_b32 v207, 0
    s_mul_i32 s27, s25, 4
    s_add_u32 s27, s27, s26
    s_mul_i32 s27, s27, 42240
    v_add_u32 v3, s27, v9
    s_lshl_b32 s27, s26, 12
    v_add_u32 v4, s27, v9
    s_mov_b32 s33, 0
    s_mov_b32 s34, 0
    buffer_load_dwordx4 v[48:51], v3, s[12:15], s34 offen offset:0
    buffer_load_dwordx4 v[52:55], v3, s[12:15], s34 offen offset:1024
    buffer_load_dwordx4 v[56:59], v3, s[12:15], s34 offen offset:2048
    buffer_load_dwordx4 v[60:63], v3, s[12:15], s34 offen offset:3072
    s_add_u32 s34, s34, 4096
    s_waitcnt vmcnt(0)
    ds_write_b128 v4, v[48:51] offset:0
    ds_write_b128 v4, v[52:55] offset:1024
    ds_write_b128 v4, v[56:59] offset:2048
    ds_write_b128 v4, v[60:63] offset:3072
    buffer_load_dwordx4 v[48:51], v3, s[12:15], s34 offen offset:0
    buffer_load_dwordx4 v[52:55], v3, s[12:15], s34 offen offset:1024
    buffer_load_dwordx4 v[56:59], v3, s[12:15], s34 offen offset:2048
    buffer_load_dwordx4 v[60:63], v3, s[12:15], s34 offen offset:3072
    s_add_u32 s34, s34, 4096
    buffer_load_dwordx4 v[16:19], v1, s[8:11], s33 offen
    buffer_load_dwordx4 v[20:23], v2, s[8:11], s33 offen
    s_add_u32 s33, s33, 1024
    buffer_load_dwordx4 v[24:27], v1, s[8:11], s33 offen
    buffer_load_dwordx4 v[28:31], v2, s[8:11], s33 offen
    s_add_u32 s33, s33, 1024
    buffer_load_dwordx4 v[32:35], v1, s[8:11], s33 offen
    buffer_load_dwordx4 v[36:39], v2, s[8:11], s33 offen
    s_add_u32 s33, s33, 1024
    buffer_load_dwordx4 v[40:43], v1, s[8:11], s33 offen
    buffer_load_dwordx4 v[44:47], v2, s[8:11], s33 offen
    s_add_u32 s33, s33, 1024
    s_waitcnt lgkmcnt(0)
    s_barrier
    s_mov_b32 s36, 0
    v_mov_b32 v5, v9
k2_kernel_loop:
    s_waitcnt vmcnt(8)
    v_xor_b32 v4, 16384, v4
    ds_write_b128 v4, v[48:51] offset:0
    ds_write_b128 v4, v[52:55] offset:1024
    ds_write_b128 v4, v[56:59] offset:2048
    ds_write_b128 v4, v[60:63] offset:3072
    s_waitcnt lgkmcnt(0)
    buffer_load_dwordx4 v[48:51], v3, s[12:15], s34 offen offset:0
    buffer_load_dwordx4 v[52:55], v3, s[12:15], s34 offen offset:1024
    buffer_load_dwordx4 v[56:59], v3, s[12:15], s34 offen offset:2048
    buffer_load_dwordx4 v[60:63], v3, s[12:15], s34 offen offset:3072
    s_add_u32 s34, s34, 4096
    ds_read_b128 v[64:67], v5 offset:0
    ds_read_b128 v[68:71], v5 offset:4096
    ds_read_b128 v[72:75], v5 offset:8192
    ds_read_b128 v[76:79], v5 offset:12288
    s_waitcnt vmcnt(10)
    s_waitcnt lgkmcnt(3)
    v_mfma_f32_32x32x16_bf16 v[80:95], v[64:67], v[16:19], v[80:95]
    v_mfma_f32_32x32x16_bf16 v[144:159], v[64:67], v[20:23], v[144:159]
    s_waitcnt lgkmcnt(2)
    v_mfma_f32_32x32x16_bf16 v[96:111], v[68:71], v[16:19], v[96:111]
    v_mfma_f32_32x32x16_bf16 v[160:175], v[68:71], v[20:23], v[160:175]
    s_waitcnt lgkmcnt(1)
    v_mfma_f32_32x32x16_bf16 v[112:127], v[72:75], v[16:19], v[112:127]
    v_mfma_f32_32x32x16_bf16 v[176:191], v[72:75], v[20:23], v[176:191]
    s_waitcnt lgkmcnt(0)
    v_mfma_f32_32x32x16_bf16 v[128:143], v[76:79], v[16:19], v[128:143]
    v_mfma_f32_32x32x16_bf16 v[192:207], v[76:79], v[20:23], v[192:207]
    buffer_load_dwordx4 v[16:19], v1, s[8:11], s33 offen
    buffer_load_dwordx4 v[20:23], v2, s[8:11], s33 offen
    s_add_u32 s33, s33, 1024
    ds_read_b128 v[64:67], v5 offset:1024
    ds_read_b128 v[68:71], v5 offset:5120
    ds_read_b128 v[72:75], v5 offset:9216
    ds_read_b128 v[76:79], v5 offset:13312
    s_waitcnt vmcnt(10)
    s_waitcnt lgkmcnt(3)
    v_mfma_f32_32x32x16_bf16 v[80:95], v[64:67], v[24:27], v[80:95]
    v_mfma_f32_32x32x16_bf16 v[144:159], v[64:67], v[28:31], v[144:159]
    s_waitcnt lgkmcnt(2)
    v_mfma_f32_32x32x16_bf16 v[96:111], v[68:71], v[24:27], v[96:111]
    v_mfma_f32_32x32x16_bf16 v[160:175], v[68:71], v[28:31], v[160:175]
    s_waitcnt lgkmcnt(1)
    v_mfma_f32_32x32x16_bf16 v[112:127], v[72:75], v[24:27], v[112:127]
    v_mfma_f32_32x32x16_bf16 v[176:191], v[72:75], v[28:31], v[176:191]
    s_waitcnt lgkmcnt(0)
    v_mfma_f32_32x32x16_bf16 v[128:143], v[76:79], v[24:27], v[128:143]
    v_mfma_f32_32x32x16_bf16 v[192:207], v[76:79], v[28:31], v[192:207]
    buffer_load_dwordx4 v[24:27], v1, s[8:11], s33 offen
    buffer_load_dwordx4 v[28:31], v2, s[8:11], s33 offen
    s_add_u32 s33, s33, 1024
    ds_read_b128 v[64:67], v5 offset:2048
    ds_read_b128 v[68:71], v5 offset:6144
    ds_read_b128 v[72:75], v5 offset:10240
    ds_read_b128 v[76:79], v5 offset:14336
    s_waitcnt vmcnt(10)
    s_waitcnt lgkmcnt(3)
    v_mfma_f32_32x32x16_bf16 v[80:95], v[64:67], v[32:35], v[80:95]
    v_mfma_f32_32x32x16_bf16 v[144:159], v[64:67], v[36:39], v[144:159]
    s_waitcnt lgkmcnt(2)
    v_mfma_f32_32x32x16_bf16 v[96:111], v[68:71], v[32:35], v[96:111]
    v_mfma_f32_32x32x16_bf16 v[160:175], v[68:71], v[36:39], v[160:175]
    s_waitcnt lgkmcnt(1)
    v_mfma_f32_32x32x16_bf16 v[112:127], v[72:75], v[32:35], v[112:127]
    v_mfma_f32_32x32x16_bf16 v[176:191], v[72:75], v[36:39], v[176:191]
    s_waitcnt lgkmcnt(0)
    v_mfma_f32_32x32x16_bf16 v[128:143], v[76:79], v[32:35], v[128:143]
    v_mfma_f32_32x32x16_bf16 v[192:207], v[76:79], v[36:39], v[192:207]
    buffer_load_dwordx4 v[32:35], v1, s[8:11], s33 offen
    buffer_load_dwordx4 v[36:39], v2, s[8:11], s33 offen
    s_add_u32 s33, s33, 1024
    ds_read_b128 v[64:67], v5 offset:3072
    ds_read_b128 v[68:71], v5 offset:7168
    ds_read_b128 v[72:75], v5 offset:11264
    ds_read_b128 v[76:79], v5 offset:15360
    s_waitcnt vmcnt(10)
    s_waitcnt lgkmcnt(3)
    v_mfma_f32_32x32x16_bf16 v[80:95], v[64:67], v[40:43], v[80:95]
    v_mfma_f32_32x32x16_bf16 v[144:159], v[64:67], v[44:47], v[144:159]
    s_waitcnt lgkmcnt(2)
    v_mfma_f32_32x32x16_bf16 v[96:111], v[68:71], v[40:43], v[96:111]
    v_mfma_f32_32x32x16_bf16 v[160:175], v[68:71], v[44:47], v[160:175]
    s_waitcnt lgkmcnt(1)
    v_mfma_f32_32x32x16_bf16 v[112:127], v[72:75], v[40:43], v[112:127]
    v_mfma_f32_32x32x16_bf16 v[176:191], v[72:75], v[44:47], v[176:191]
    s_waitcnt lgkmcnt(0)
    v_mfma_f32_32x32x16_bf16 v[128:143], v[76:79], v[40:43], v[128:143]
    v_mfma_f32_32x32x16_bf16 v[192:207], v[76:79], v[44:47], v[192:207]
    buffer_load_dwordx4 v[40:43], v1, s[8:11], s33 offen
    buffer_load_dwordx4 v[44:47], v2, s[8:11], s33 offen
    s_add_u32 s33, s33, 1024
    v_xor_b32 v5, 16384, v5
    s_barrier
    s_add_u32 s36, s36, 1
    s_cmp_lt_u32 s36, 10
    s_cbranch_scc1 k2_kernel_loop
    s_nop 15
    v_and_b32 v10, 31, v0
    v_bfe_u32 v11, v0, 5, 1
    s_lshl_b32 s40, s24, 1
    s_add_u32 s40, s40, 0
    s_mul_i32 s40, s40, 111872
    s_lshl_b32 s41, s25, 12
    s_add_u32 s40, s40, s41
    s_add_u32 s40, s40, 0
    v_lshlrev_b32 v12, 4, v10
    v_lshl_add_u32 v12, v11, 3, v12
    v_cvt_pk_bf16_f32 v80, v80, v80
    v_lshlrev_b32 v80, 16, v80
    v_cvt_pk_bf16_f32 v96, v96, v96
    v_lshlrev_b32 v96, 16, v96
    v_mul_f32 v80, 0xbfb8aa3b, v80
    v_exp_f32 v80, v80
    s_nop 0
    v_add_f32 v80, 1.0, v80
    v_rcp_f32 v80, v80
    s_nop 0
    v_cvt_pk_bf16_f32 v80, v80, v80
    v_lshlrev_b32 v80, 16, v80
    v_mul_f32 v80, v80, v96
    v_cvt_pk_bf16_f32 v81, v81, v81
    v_lshlrev_b32 v81, 16, v81
    v_cvt_pk_bf16_f32 v97, v97, v97
    v_lshlrev_b32 v97, 16, v97
    v_mul_f32 v81, 0xbfb8aa3b, v81
    v_exp_f32 v81, v81
    s_nop 0
    v_add_f32 v81, 1.0, v81
    v_rcp_f32 v81, v81
    s_nop 0
    v_cvt_pk_bf16_f32 v81, v81, v81
    v_lshlrev_b32 v81, 16, v81
    v_mul_f32 v81, v81, v97
    v_cvt_pk_bf16_f32 v82, v82, v82
    v_lshlrev_b32 v82, 16, v82
    v_cvt_pk_bf16_f32 v98, v98, v98
    v_lshlrev_b32 v98, 16, v98
    v_mul_f32 v82, 0xbfb8aa3b, v82
    v_exp_f32 v82, v82
    s_nop 0
    v_add_f32 v82, 1.0, v82
    v_rcp_f32 v82, v82
    s_nop 0
    v_cvt_pk_bf16_f32 v82, v82, v82
    v_lshlrev_b32 v82, 16, v82
    v_mul_f32 v82, v82, v98
    v_cvt_pk_bf16_f32 v83, v83, v83
    v_lshlrev_b32 v83, 16, v83
    v_cvt_pk_bf16_f32 v99, v99, v99
    v_lshlrev_b32 v99, 16, v99
    v_mul_f32 v83, 0xbfb8aa3b, v83
    v_exp_f32 v83, v83
    s_nop 0
    v_add_f32 v83, 1.0, v83
    v_rcp_f32 v83, v83
    s_nop 0
    v_cvt_pk_bf16_f32 v83, v83, v83
    v_lshlrev_b32 v83, 16, v83
    v_mul_f32 v83, v83, v99
    v_cvt_pk_bf16_f32 v84, v84, v84
    v_lshlrev_b32 v84, 16, v84
    v_cvt_pk_bf16_f32 v100, v100, v100
    v_lshlrev_b32 v100, 16, v100
    v_mul_f32 v84, 0xbfb8aa3b, v84
    v_exp_f32 v84, v84
    s_nop 0
    v_add_f32 v84, 1.0, v84
    v_rcp_f32 v84, v84
    s_nop 0
    v_cvt_pk_bf16_f32 v84, v84, v84
    v_lshlrev_b32 v84, 16, v84
    v_mul_f32 v84, v84, v100
    v_cvt_pk_bf16_f32 v85, v85, v85
    v_lshlrev_b32 v85, 16, v85
    v_cvt_pk_bf16_f32 v101, v101, v101
    v_lshlrev_b32 v101, 16, v101
    v_mul_f32 v85, 0xbfb8aa3b, v85
    v_exp_f32 v85, v85
    s_nop 0
    v_add_f32 v85, 1.0, v85
    v_rcp_f32 v85, v85
    s_nop 0
    v_cvt_pk_bf16_f32 v85, v85, v85
    v_lshlrev_b32 v85, 16, v85
    v_mul_f32 v85, v85, v101
    v_cvt_pk_bf16_f32 v86, v86, v86
    v_lshlrev_b32 v86, 16, v86
    v_cvt_pk_bf16_f32 v102, v102, v102
    v_lshlrev_b32 v102, 16, v102
    v_mul_f32 v86, 0xbfb8aa3b, v86
    v_exp_f32 v86, v86
    s_nop 0
    v_add_f32 v86, 1.0, v86
    v_rcp_f32 v86, v86
    s_nop 0
    v_cvt_pk_bf16_f32 v86, v86, v86
    v_lshlrev_b32 v86, 16, v86
    v_mul_f32 v86, v86, v102
    v_cvt_pk_bf16_f32 v87, v87, v87
    v_lshlrev_b32 v87, 16, v87
    v_cvt_pk_bf16_f32 v103, v103, v103
    v_lshlrev_b32 v103, 16, v103
    v_mul_f32 v87, 0xbfb8aa3b, v87
    v_exp_f32 v87, v87
    s_nop 0
    v_add_f32 v87, 1.0, v87
    v_rcp_f32 v87, v87
    s_nop 0
    v_cvt_pk_bf16_f32 v87, v87, v87
    v_lshlrev_b32 v87, 16, v87
    v_mul_f32 v87, v87, v103
    v_cvt_pk_bf16_f32 v88, v88, v88
    v_lshlrev_b32 v88, 16, v88
    v_cvt_pk_bf16_f32 v104, v104, v104
    v_lshlrev_b32 v104, 16, v104
    v_mul_f32 v88, 0xbfb8aa3b, v88
    v_exp_f32 v88, v88
    s_nop 0
    v_add_f32 v88, 1.0, v88
    v_rcp_f32 v88, v88
    s_nop 0
    v_cvt_pk_bf16_f32 v88, v88, v88
    v_lshlrev_b32 v88, 16, v88
    v_mul_f32 v88, v88, v104
    v_cvt_pk_bf16_f32 v89, v89, v89
    v_lshlrev_b32 v89, 16, v89
    v_cvt_pk_bf16_f32 v105, v105, v105
    v_lshlrev_b32 v105, 16, v105
    v_mul_f32 v89, 0xbfb8aa3b, v89
    v_exp_f32 v89, v89
    s_nop 0
    v_add_f32 v89, 1.0, v89
    v_rcp_f32 v89, v89
    s_nop 0
    v_cvt_pk_bf16_f32 v89, v89, v89
    v_lshlrev_b32 v89, 16, v89
    v_mul_f32 v89, v89, v105
    v_cvt_pk_bf16_f32 v90, v90, v90
    v_lshlrev_b32 v90, 16, v90
    v_cvt_pk_bf16_f32 v106, v106, v106
    v_lshlrev_b32 v106, 16, v106
    v_mul_f32 v90, 0xbfb8aa3b, v90
    v_exp_f32 v90, v90
    s_nop 0
    v_add_f32 v90, 1.0, v90
    v_rcp_f32 v90, v90
    s_nop 0
    v_cvt_pk_bf16_f32 v90, v90, v90
    v_lshlrev_b32 v90, 16, v90
    v_mul_f32 v90, v90, v106
    v_cvt_pk_bf16_f32 v91, v91, v91
    v_lshlrev_b32 v91, 16, v91
    v_cvt_pk_bf16_f32 v107, v107, v107
    v_lshlrev_b32 v107, 16, v107
    v_mul_f32 v91, 0xbfb8aa3b, v91
    v_exp_f32 v91, v91
    s_nop 0
    v_add_f32 v91, 1.0, v91
    v_rcp_f32 v91, v91
    s_nop 0
    v_cvt_pk_bf16_f32 v91, v91, v91
    v_lshlrev_b32 v91, 16, v91
    v_mul_f32 v91, v91, v107
    v_cvt_pk_bf16_f32 v92, v92, v92
    v_lshlrev_b32 v92, 16, v92
    v_cvt_pk_bf16_f32 v108, v108, v108
    v_lshlrev_b32 v108, 16, v108
    v_mul_f32 v92, 0xbfb8aa3b, v92
    v_exp_f32 v92, v92
    s_nop 0
    v_add_f32 v92, 1.0, v92
    v_rcp_f32 v92, v92
    s_nop 0
    v_cvt_pk_bf16_f32 v92, v92, v92
    v_lshlrev_b32 v92, 16, v92
    v_mul_f32 v92, v92, v108
    v_cvt_pk_bf16_f32 v93, v93, v93
    v_lshlrev_b32 v93, 16, v93
    v_cvt_pk_bf16_f32 v109, v109, v109
    v_lshlrev_b32 v109, 16, v109
    v_mul_f32 v93, 0xbfb8aa3b, v93
    v_exp_f32 v93, v93
    s_nop 0
    v_add_f32 v93, 1.0, v93
    v_rcp_f32 v93, v93
    s_nop 0
    v_cvt_pk_bf16_f32 v93, v93, v93
    v_lshlrev_b32 v93, 16, v93
    v_mul_f32 v93, v93, v109
    v_cvt_pk_bf16_f32 v94, v94, v94
    v_lshlrev_b32 v94, 16, v94
    v_cvt_pk_bf16_f32 v110, v110, v110
    v_lshlrev_b32 v110, 16, v110
    v_mul_f32 v94, 0xbfb8aa3b, v94
    v_exp_f32 v94, v94
    s_nop 0
    v_add_f32 v94, 1.0, v94
    v_rcp_f32 v94, v94
    s_nop 0
    v_cvt_pk_bf16_f32 v94, v94, v94
    v_lshlrev_b32 v94, 16, v94
    v_mul_f32 v94, v94, v110
    v_cvt_pk_bf16_f32 v95, v95, v95
    v_lshlrev_b32 v95, 16, v95
    v_cvt_pk_bf16_f32 v111, v111, v111
    v_lshlrev_b32 v111, 16, v111
    v_mul_f32 v95, 0xbfb8aa3b, v95
    v_exp_f32 v95, v95
    s_nop 0
    v_add_f32 v95, 1.0, v95
    v_rcp_f32 v95, v95
    s_nop 0
    v_cvt_pk_bf16_f32 v95, v95, v95
    v_lshlrev_b32 v95, 16, v95
    v_mul_f32 v95, v95, v111
    v_cvt_pk_bf16_f32 v14, v80, v81
    v_cvt_pk_bf16_f32 v15, v82, v83
    buffer_store_dwordx2 v[14:15], v12, s[16:19], s40 offen offset:0
    s_nop 1
    v_cvt_pk_bf16_f32 v14, v84, v85
    v_cvt_pk_bf16_f32 v15, v86, v87
    buffer_store_dwordx2 v[14:15], v12, s[16:19], s40 offen offset:512
    s_nop 1
    v_cvt_pk_bf16_f32 v14, v88, v89
    v_cvt_pk_bf16_f32 v15, v90, v91
    buffer_store_dwordx2 v[14:15], v12, s[16:19], s40 offen offset:1024
    s_nop 1
    v_cvt_pk_bf16_f32 v14, v92, v93
    v_cvt_pk_bf16_f32 v15, v94, v95
    buffer_store_dwordx2 v[14:15], v12, s[16:19], s40 offen offset:1536
    s_nop 1
    s_lshl_b32 s40, s24, 1
    s_add_u32 s40, s40, 0
    s_mul_i32 s40, s40, 111872
    s_lshl_b32 s41, s25, 12
    s_add_u32 s40, s40, s41
    s_add_u32 s40, s40, 2048
    v_lshlrev_b32 v12, 4, v10
    v_lshl_add_u32 v12, v11, 3, v12
    v_cvt_pk_bf16_f32 v112, v112, v112
    v_lshlrev_b32 v112, 16, v112
    v_cvt_pk_bf16_f32 v128, v128, v128
    v_lshlrev_b32 v128, 16, v128
    v_mul_f32 v112, 0xbfb8aa3b, v112
    v_exp_f32 v112, v112
    s_nop 0
    v_add_f32 v112, 1.0, v112
    v_rcp_f32 v112, v112
    s_nop 0
    v_cvt_pk_bf16_f32 v112, v112, v112
    v_lshlrev_b32 v112, 16, v112
    v_mul_f32 v112, v112, v128
    v_cvt_pk_bf16_f32 v113, v113, v113
    v_lshlrev_b32 v113, 16, v113
    v_cvt_pk_bf16_f32 v129, v129, v129
    v_lshlrev_b32 v129, 16, v129
    v_mul_f32 v113, 0xbfb8aa3b, v113
    v_exp_f32 v113, v113
    s_nop 0
    v_add_f32 v113, 1.0, v113
    v_rcp_f32 v113, v113
    s_nop 0
    v_cvt_pk_bf16_f32 v113, v113, v113
    v_lshlrev_b32 v113, 16, v113
    v_mul_f32 v113, v113, v129
    v_cvt_pk_bf16_f32 v114, v114, v114
    v_lshlrev_b32 v114, 16, v114
    v_cvt_pk_bf16_f32 v130, v130, v130
    v_lshlrev_b32 v130, 16, v130
    v_mul_f32 v114, 0xbfb8aa3b, v114
    v_exp_f32 v114, v114
    s_nop 0
    v_add_f32 v114, 1.0, v114
    v_rcp_f32 v114, v114
    s_nop 0
    v_cvt_pk_bf16_f32 v114, v114, v114
    v_lshlrev_b32 v114, 16, v114
    v_mul_f32 v114, v114, v130
    v_cvt_pk_bf16_f32 v115, v115, v115
    v_lshlrev_b32 v115, 16, v115
    v_cvt_pk_bf16_f32 v131, v131, v131
    v_lshlrev_b32 v131, 16, v131
    v_mul_f32 v115, 0xbfb8aa3b, v115
    v_exp_f32 v115, v115
    s_nop 0
    v_add_f32 v115, 1.0, v115
    v_rcp_f32 v115, v115
    s_nop 0
    v_cvt_pk_bf16_f32 v115, v115, v115
    v_lshlrev_b32 v115, 16, v115
    v_mul_f32 v115, v115, v131
    v_cvt_pk_bf16_f32 v116, v116, v116
    v_lshlrev_b32 v116, 16, v116
    v_cvt_pk_bf16_f32 v132, v132, v132
    v_lshlrev_b32 v132, 16, v132
    v_mul_f32 v116, 0xbfb8aa3b, v116
    v_exp_f32 v116, v116
    s_nop 0
    v_add_f32 v116, 1.0, v116
    v_rcp_f32 v116, v116
    s_nop 0
    v_cvt_pk_bf16_f32 v116, v116, v116
    v_lshlrev_b32 v116, 16, v116
    v_mul_f32 v116, v116, v132
    v_cvt_pk_bf16_f32 v117, v117, v117
    v_lshlrev_b32 v117, 16, v117
    v_cvt_pk_bf16_f32 v133, v133, v133
    v_lshlrev_b32 v133, 16, v133
    v_mul_f32 v117, 0xbfb8aa3b, v117
    v_exp_f32 v117, v117
    s_nop 0
    v_add_f32 v117, 1.0, v117
    v_rcp_f32 v117, v117
    s_nop 0
    v_cvt_pk_bf16_f32 v117, v117, v117
    v_lshlrev_b32 v117, 16, v117
    v_mul_f32 v117, v117, v133
    v_cvt_pk_bf16_f32 v118, v118, v118
    v_lshlrev_b32 v118, 16, v118
    v_cvt_pk_bf16_f32 v134, v134, v134
    v_lshlrev_b32 v134, 16, v134
    v_mul_f32 v118, 0xbfb8aa3b, v118
    v_exp_f32 v118, v118
    s_nop 0
    v_add_f32 v118, 1.0, v118
    v_rcp_f32 v118, v118
    s_nop 0
    v_cvt_pk_bf16_f32 v118, v118, v118
    v_lshlrev_b32 v118, 16, v118
    v_mul_f32 v118, v118, v134
    v_cvt_pk_bf16_f32 v119, v119, v119
    v_lshlrev_b32 v119, 16, v119
    v_cvt_pk_bf16_f32 v135, v135, v135
    v_lshlrev_b32 v135, 16, v135
    v_mul_f32 v119, 0xbfb8aa3b, v119
    v_exp_f32 v119, v119
    s_nop 0
    v_add_f32 v119, 1.0, v119
    v_rcp_f32 v119, v119
    s_nop 0
    v_cvt_pk_bf16_f32 v119, v119, v119
    v_lshlrev_b32 v119, 16, v119
    v_mul_f32 v119, v119, v135
    v_cvt_pk_bf16_f32 v120, v120, v120
    v_lshlrev_b32 v120, 16, v120
    v_cvt_pk_bf16_f32 v136, v136, v136
    v_lshlrev_b32 v136, 16, v136
    v_mul_f32 v120, 0xbfb8aa3b, v120
    v_exp_f32 v120, v120
    s_nop 0
    v_add_f32 v120, 1.0, v120
    v_rcp_f32 v120, v120
    s_nop 0
    v_cvt_pk_bf16_f32 v120, v120, v120
    v_lshlrev_b32 v120, 16, v120
    v_mul_f32 v120, v120, v136
    v_cvt_pk_bf16_f32 v121, v121, v121
    v_lshlrev_b32 v121, 16, v121
    v_cvt_pk_bf16_f32 v137, v137, v137
    v_lshlrev_b32 v137, 16, v137
    v_mul_f32 v121, 0xbfb8aa3b, v121
    v_exp_f32 v121, v121
    s_nop 0
    v_add_f32 v121, 1.0, v121
    v_rcp_f32 v121, v121
    s_nop 0
    v_cvt_pk_bf16_f32 v121, v121, v121
    v_lshlrev_b32 v121, 16, v121
    v_mul_f32 v121, v121, v137
    v_cvt_pk_bf16_f32 v122, v122, v122
    v_lshlrev_b32 v122, 16, v122
    v_cvt_pk_bf16_f32 v138, v138, v138
    v_lshlrev_b32 v138, 16, v138
    v_mul_f32 v122, 0xbfb8aa3b, v122
    v_exp_f32 v122, v122
    s_nop 0
    v_add_f32 v122, 1.0, v122
    v_rcp_f32 v122, v122
    s_nop 0
    v_cvt_pk_bf16_f32 v122, v122, v122
    v_lshlrev_b32 v122, 16, v122
    v_mul_f32 v122, v122, v138
    v_cvt_pk_bf16_f32 v123, v123, v123
    v_lshlrev_b32 v123, 16, v123
    v_cvt_pk_bf16_f32 v139, v139, v139
    v_lshlrev_b32 v139, 16, v139
    v_mul_f32 v123, 0xbfb8aa3b, v123
    v_exp_f32 v123, v123
    s_nop 0
    v_add_f32 v123, 1.0, v123
    v_rcp_f32 v123, v123
    s_nop 0
    v_cvt_pk_bf16_f32 v123, v123, v123
    v_lshlrev_b32 v123, 16, v123
    v_mul_f32 v123, v123, v139
    v_cvt_pk_bf16_f32 v124, v124, v124
    v_lshlrev_b32 v124, 16, v124
    v_cvt_pk_bf16_f32 v140, v140, v140
    v_lshlrev_b32 v140, 16, v140
    v_mul_f32 v124, 0xbfb8aa3b, v124
    v_exp_f32 v124, v124
    s_nop 0
    v_add_f32 v124, 1.0, v124
    v_rcp_f32 v124, v124
    s_nop 0
    v_cvt_pk_bf16_f32 v124, v124, v124
    v_lshlrev_b32 v124, 16, v124
    v_mul_f32 v124, v124, v140
    v_cvt_pk_bf16_f32 v125, v125, v125
    v_lshlrev_b32 v125, 16, v125
    v_cvt_pk_bf16_f32 v141, v141, v141
    v_lshlrev_b32 v141, 16, v141
    v_mul_f32 v125, 0xbfb8aa3b, v125
    v_exp_f32 v125, v125
    s_nop 0
    v_add_f32 v125, 1.0, v125
    v_rcp_f32 v125, v125
    s_nop 0
    v_cvt_pk_bf16_f32 v125, v125, v125
    v_lshlrev_b32 v125, 16, v125
    v_mul_f32 v125, v125, v141
    v_cvt_pk_bf16_f32 v126, v126, v126
    v_lshlrev_b32 v126, 16, v126
    v_cvt_pk_bf16_f32 v142, v142, v142
    v_lshlrev_b32 v142, 16, v142
    v_mul_f32 v126, 0xbfb8aa3b, v126
    v_exp_f32 v126, v126
    s_nop 0
    v_add_f32 v126, 1.0, v126
    v_rcp_f32 v126, v126
    s_nop 0
    v_cvt_pk_bf16_f32 v126, v126, v126
    v_lshlrev_b32 v126, 16, v126
    v_mul_f32 v126, v126, v142
    v_cvt_pk_bf16_f32 v127, v127, v127
    v_lshlrev_b32 v127, 16, v127
    v_cvt_pk_bf16_f32 v143, v143, v143
    v_lshlrev_b32 v143, 16, v143
    v_mul_f32 v127, 0xbfb8aa3b, v127
    v_exp_f32 v127, v127
    s_nop 0
    v_add_f32 v127, 1.0, v127
    v_rcp_f32 v127, v127
    s_nop 0
    v_cvt_pk_bf16_f32 v127, v127, v127
    v_lshlrev_b32 v127, 16, v127
    v_mul_f32 v127, v127, v143
    v_cvt_pk_bf16_f32 v14, v112, v113
    v_cvt_pk_bf16_f32 v15, v114, v115
    buffer_store_dwordx2 v[14:15], v12, s[16:19], s40 offen offset:0
    s_nop 1
    v_cvt_pk_bf16_f32 v14, v116, v117
    v_cvt_pk_bf16_f32 v15, v118, v119
    buffer_store_dwordx2 v[14:15], v12, s[16:19], s40 offen offset:512
    s_nop 1
    v_cvt_pk_bf16_f32 v14, v120, v121
    v_cvt_pk_bf16_f32 v15, v122, v123
    buffer_store_dwordx2 v[14:15], v12, s[16:19], s40 offen offset:1024
    s_nop 1
    v_cvt_pk_bf16_f32 v14, v124, v125
    v_cvt_pk_bf16_f32 v15, v126, v127
    buffer_store_dwordx2 v[14:15], v12, s[16:19], s40 offen offset:1536
    s_nop 1
    s_lshl_b32 s40, s24, 1
    s_add_u32 s40, s40, 1
    s_mul_i32 s40, s40, 111872
    s_lshl_b32 s41, s25, 12
    s_add_u32 s40, s40, s41
    s_add_u32 s40, s40, 0
    v_lshlrev_b32 v12, 4, v10
    v_lshl_add_u32 v12, v11, 3, v12
    v_cvt_pk_bf16_f32 v144, v144, v144
    v_lshlrev_b32 v144, 16, v144
    v_cvt_pk_bf16_f32 v160, v160, v160
    v_lshlrev_b32 v160, 16, v160
    v_mul_f32 v144, 0xbfb8aa3b, v144
    v_exp_f32 v144, v144
    s_nop 0
    v_add_f32 v144, 1.0, v144
    v_rcp_f32 v144, v144
    s_nop 0
    v_cvt_pk_bf16_f32 v144, v144, v144
    v_lshlrev_b32 v144, 16, v144
    v_mul_f32 v144, v144, v160
    v_cvt_pk_bf16_f32 v145, v145, v145
    v_lshlrev_b32 v145, 16, v145
    v_cvt_pk_bf16_f32 v161, v161, v161
    v_lshlrev_b32 v161, 16, v161
    v_mul_f32 v145, 0xbfb8aa3b, v145
    v_exp_f32 v145, v145
    s_nop 0
    v_add_f32 v145, 1.0, v145
    v_rcp_f32 v145, v145
    s_nop 0
    v_cvt_pk_bf16_f32 v145, v145, v145
    v_lshlrev_b32 v145, 16, v145
    v_mul_f32 v145, v145, v161
    v_cvt_pk_bf16_f32 v146, v146, v146
    v_lshlrev_b32 v146, 16, v146
    v_cvt_pk_bf16_f32 v162, v162, v162
    v_lshlrev_b32 v162, 16, v162
    v_mul_f32 v146, 0xbfb8aa3b, v146
    v_exp_f32 v146, v146
    s_nop 0
    v_add_f32 v146, 1.0, v146
    v_rcp_f32 v146, v146
    s_nop 0
    v_cvt_pk_bf16_f32 v146, v146, v146
    v_lshlrev_b32 v146, 16, v146
    v_mul_f32 v146, v146, v162
    v_cvt_pk_bf16_f32 v147, v147, v147
    v_lshlrev_b32 v147, 16, v147
    v_cvt_pk_bf16_f32 v163, v163, v163
    v_lshlrev_b32 v163, 16, v163
    v_mul_f32 v147, 0xbfb8aa3b, v147
    v_exp_f32 v147, v147
    s_nop 0
    v_add_f32 v147, 1.0, v147
    v_rcp_f32 v147, v147
    s_nop 0
    v_cvt_pk_bf16_f32 v147, v147, v147
    v_lshlrev_b32 v147, 16, v147
    v_mul_f32 v147, v147, v163
    v_cvt_pk_bf16_f32 v148, v148, v148
    v_lshlrev_b32 v148, 16, v148
    v_cvt_pk_bf16_f32 v164, v164, v164
    v_lshlrev_b32 v164, 16, v164
    v_mul_f32 v148, 0xbfb8aa3b, v148
    v_exp_f32 v148, v148
    s_nop 0
    v_add_f32 v148, 1.0, v148
    v_rcp_f32 v148, v148
    s_nop 0
    v_cvt_pk_bf16_f32 v148, v148, v148
    v_lshlrev_b32 v148, 16, v148
    v_mul_f32 v148, v148, v164
    v_cvt_pk_bf16_f32 v149, v149, v149
    v_lshlrev_b32 v149, 16, v149
    v_cvt_pk_bf16_f32 v165, v165, v165
    v_lshlrev_b32 v165, 16, v165
    v_mul_f32 v149, 0xbfb8aa3b, v149
    v_exp_f32 v149, v149
    s_nop 0
    v_add_f32 v149, 1.0, v149
    v_rcp_f32 v149, v149
    s_nop 0
    v_cvt_pk_bf16_f32 v149, v149, v149
    v_lshlrev_b32 v149, 16, v149
    v_mul_f32 v149, v149, v165
    v_cvt_pk_bf16_f32 v150, v150, v150
    v_lshlrev_b32 v150, 16, v150
    v_cvt_pk_bf16_f32 v166, v166, v166
    v_lshlrev_b32 v166, 16, v166
    v_mul_f32 v150, 0xbfb8aa3b, v150
    v_exp_f32 v150, v150
    s_nop 0
    v_add_f32 v150, 1.0, v150
    v_rcp_f32 v150, v150
    s_nop 0
    v_cvt_pk_bf16_f32 v150, v150, v150
    v_lshlrev_b32 v150, 16, v150
    v_mul_f32 v150, v150, v166
    v_cvt_pk_bf16_f32 v151, v151, v151
    v_lshlrev_b32 v151, 16, v151
    v_cvt_pk_bf16_f32 v167, v167, v167
    v_lshlrev_b32 v167, 16, v167
    v_mul_f32 v151, 0xbfb8aa3b, v151
    v_exp_f32 v151, v151
    s_nop 0
    v_add_f32 v151, 1.0, v151
    v_rcp_f32 v151, v151
    s_nop 0
    v_cvt_pk_bf16_f32 v151, v151, v151
    v_lshlrev_b32 v151, 16, v151
    v_mul_f32 v151, v151, v167
    v_cvt_pk_bf16_f32 v152, v152, v152
    v_lshlrev_b32 v152, 16, v152
    v_cvt_pk_bf16_f32 v168, v168, v168
    v_lshlrev_b32 v168, 16, v168
    v_mul_f32 v152, 0xbfb8aa3b, v152
    v_exp_f32 v152, v152
    s_nop 0
    v_add_f32 v152, 1.0, v152
    v_rcp_f32 v152, v152
    s_nop 0
    v_cvt_pk_bf16_f32 v152, v152, v152
    v_lshlrev_b32 v152, 16, v152
    v_mul_f32 v152, v152, v168
    v_cvt_pk_bf16_f32 v153, v153, v153
    v_lshlrev_b32 v153, 16, v153
    v_cvt_pk_bf16_f32 v169, v169, v169
    v_lshlrev_b32 v169, 16, v169
    v_mul_f32 v153, 0xbfb8aa3b, v153
    v_exp_f32 v153, v153
    s_nop 0
    v_add_f32 v153, 1.0, v153
    v_rcp_f32 v153, v153
    s_nop 0
    v_cvt_pk_bf16_f32 v153, v153, v153
    v_lshlrev_b32 v153, 16, v153
    v_mul_f32 v153, v153, v169
    v_cvt_pk_bf16_f32 v154, v154, v154
    v_lshlrev_b32 v154, 16, v154
    v_cvt_pk_bf16_f32 v170, v170, v170
    v_lshlrev_b32 v170, 16, v170
    v_mul_f32 v154, 0xbfb8aa3b, v154
    v_exp_f32 v154, v154
    s_nop 0
    v_add_f32 v154, 1.0, v154
    v_rcp_f32 v154, v154
    s_nop 0
    v_cvt_pk_bf16_f32 v154, v154, v154
    v_lshlrev_b32 v154, 16, v154
    v_mul_f32 v154, v154, v170
    v_cvt_pk_bf16_f32 v155, v155, v155
    v_lshlrev_b32 v155, 16, v155
    v_cvt_pk_bf16_f32 v171, v171, v171
    v_lshlrev_b32 v171, 16, v171
    v_mul_f32 v155, 0xbfb8aa3b, v155
    v_exp_f32 v155, v155
    s_nop 0
    v_add_f32 v155, 1.0, v155
    v_rcp_f32 v155, v155
    s_nop 0
    v_cvt_pk_bf16_f32 v155, v155, v155
    v_lshlrev_b32 v155, 16, v155
    v_mul_f32 v155, v155, v171
    v_cvt_pk_bf16_f32 v156, v156, v156
    v_lshlrev_b32 v156, 16, v156
    v_cvt_pk_bf16_f32 v172, v172, v172
    v_lshlrev_b32 v172, 16, v172
    v_mul_f32 v156, 0xbfb8aa3b, v156
    v_exp_f32 v156, v156
    s_nop 0
    v_add_f32 v156, 1.0, v156
    v_rcp_f32 v156, v156
    s_nop 0
    v_cvt_pk_bf16_f32 v156, v156, v156
    v_lshlrev_b32 v156, 16, v156
    v_mul_f32 v156, v156, v172
    v_cvt_pk_bf16_f32 v157, v157, v157
    v_lshlrev_b32 v157, 16, v157
    v_cvt_pk_bf16_f32 v173, v173, v173
    v_lshlrev_b32 v173, 16, v173
    v_mul_f32 v157, 0xbfb8aa3b, v157
    v_exp_f32 v157, v157
    s_nop 0
    v_add_f32 v157, 1.0, v157
    v_rcp_f32 v157, v157
    s_nop 0
    v_cvt_pk_bf16_f32 v157, v157, v157
    v_lshlrev_b32 v157, 16, v157
    v_mul_f32 v157, v157, v173
    v_cvt_pk_bf16_f32 v158, v158, v158
    v_lshlrev_b32 v158, 16, v158
    v_cvt_pk_bf16_f32 v174, v174, v174
    v_lshlrev_b32 v174, 16, v174
    v_mul_f32 v158, 0xbfb8aa3b, v158
    v_exp_f32 v158, v158
    s_nop 0
    v_add_f32 v158, 1.0, v158
    v_rcp_f32 v158, v158
    s_nop 0
    v_cvt_pk_bf16_f32 v158, v158, v158
    v_lshlrev_b32 v158, 16, v158
    v_mul_f32 v158, v158, v174
    v_cvt_pk_bf16_f32 v159, v159, v159
    v_lshlrev_b32 v159, 16, v159
    v_cvt_pk_bf16_f32 v175, v175, v175
    v_lshlrev_b32 v175, 16, v175
    v_mul_f32 v159, 0xbfb8aa3b, v159
    v_exp_f32 v159, v159
    s_nop 0
    v_add_f32 v159, 1.0, v159
    v_rcp_f32 v159, v159
    s_nop 0
    v_cvt_pk_bf16_f32 v159, v159, v159
    v_lshlrev_b32 v159, 16, v159
    v_mul_f32 v159, v159, v175
    v_cvt_pk_bf16_f32 v14, v144, v145
    v_cvt_pk_bf16_f32 v15, v146, v147
    buffer_store_dwordx2 v[14:15], v12, s[16:19], s40 offen offset:0
    s_nop 1
    v_cvt_pk_bf16_f32 v14, v148, v149
    v_cvt_pk_bf16_f32 v15, v150, v151
    buffer_store_dwordx2 v[14:15], v12, s[16:19], s40 offen offset:512
    s_nop 1
    v_cvt_pk_bf16_f32 v14, v152, v153
    v_cvt_pk_bf16_f32 v15, v154, v155
    buffer_store_dwordx2 v[14:15], v12, s[16:19], s40 offen offset:1024
    s_nop 1
    v_cvt_pk_bf16_f32 v14, v156, v157
    v_cvt_pk_bf16_f32 v15, v158, v159
    buffer_store_dwordx2 v[14:15], v12, s[16:19], s40 offen offset:1536
    s_nop 1
    s_lshl_b32 s40, s24, 1
    s_add_u32 s40, s40, 1
    s_mul_i32 s40, s40, 111872
    s_lshl_b32 s41, s25, 12
    s_add_u32 s40, s40, s41
    s_add_u32 s40, s40, 2048
    v_lshlrev_b32 v12, 4, v10
    v_lshl_add_u32 v12, v11, 3, v12
    v_cvt_pk_bf16_f32 v176, v176, v176
    v_lshlrev_b32 v176, 16, v176
    v_cvt_pk_bf16_f32 v192, v192, v192
    v_lshlrev_b32 v192, 16, v192
    v_mul_f32 v176, 0xbfb8aa3b, v176
    v_exp_f32 v176, v176
    s_nop 0
    v_add_f32 v176, 1.0, v176
    v_rcp_f32 v176, v176
    s_nop 0
    v_cvt_pk_bf16_f32 v176, v176, v176
    v_lshlrev_b32 v176, 16, v176
    v_mul_f32 v176, v176, v192
    v_cvt_pk_bf16_f32 v177, v177, v177
    v_lshlrev_b32 v177, 16, v177
    v_cvt_pk_bf16_f32 v193, v193, v193
    v_lshlrev_b32 v193, 16, v193
    v_mul_f32 v177, 0xbfb8aa3b, v177
    v_exp_f32 v177, v177
    s_nop 0
    v_add_f32 v177, 1.0, v177
    v_rcp_f32 v177, v177
    s_nop 0
    v_cvt_pk_bf16_f32 v177, v177, v177
    v_lshlrev_b32 v177, 16, v177
    v_mul_f32 v177, v177, v193
    v_cvt_pk_bf16_f32 v178, v178, v178
    v_lshlrev_b32 v178, 16, v178
    v_cvt_pk_bf16_f32 v194, v194, v194
    v_lshlrev_b32 v194, 16, v194
    v_mul_f32 v178, 0xbfb8aa3b, v178
    v_exp_f32 v178, v178
    s_nop 0
    v_add_f32 v178, 1.0, v178
    v_rcp_f32 v178, v178
    s_nop 0
    v_cvt_pk_bf16_f32 v178, v178, v178
    v_lshlrev_b32 v178, 16, v178
    v_mul_f32 v178, v178, v194
    v_cvt_pk_bf16_f32 v179, v179, v179
    v_lshlrev_b32 v179, 16, v179
    v_cvt_pk_bf16_f32 v195, v195, v195
    v_lshlrev_b32 v195, 16, v195
    v_mul_f32 v179, 0xbfb8aa3b, v179
    v_exp_f32 v179, v179
    s_nop 0
    v_add_f32 v179, 1.0, v179
    v_rcp_f32 v179, v179
    s_nop 0
    v_cvt_pk_bf16_f32 v179, v179, v179
    v_lshlrev_b32 v179, 16, v179
    v_mul_f32 v179, v179, v195
    v_cvt_pk_bf16_f32 v180, v180, v180
    v_lshlrev_b32 v180, 16, v180
    v_cvt_pk_bf16_f32 v196, v196, v196
    v_lshlrev_b32 v196, 16, v196
    v_mul_f32 v180, 0xbfb8aa3b, v180
    v_exp_f32 v180, v180
    s_nop 0
    v_add_f32 v180, 1.0, v180
    v_rcp_f32 v180, v180
    s_nop 0
    v_cvt_pk_bf16_f32 v180, v180, v180
    v_lshlrev_b32 v180, 16, v180
    v_mul_f32 v180, v180, v196
    v_cvt_pk_bf16_f32 v181, v181, v181
    v_lshlrev_b32 v181, 16, v181
    v_cvt_pk_bf16_f32 v197, v197, v197
    v_lshlrev_b32 v197, 16, v197
    v_mul_f32 v181, 0xbfb8aa3b, v181
    v_exp_f32 v181, v181
    s_nop 0
    v_add_f32 v181, 1.0, v181
    v_rcp_f32 v181, v181
    s_nop 0
    v_cvt_pk_bf16_f32 v181, v181, v181
    v_lshlrev_b32 v181, 16, v181
    v_mul_f32 v181, v181, v197
    v_cvt_pk_bf16_f32 v182, v182, v182
    v_lshlrev_b32 v182, 16, v182
    v_cvt_pk_bf16_f32 v198, v198, v198
    v_lshlrev_b32 v198, 16, v198
    v_mul_f32 v182, 0xbfb8aa3b, v182
    v_exp_f32 v182, v182
    s_nop 0
    v_add_f32 v182, 1.0, v182
    v_rcp_f32 v182, v182
    s_nop 0
    v_cvt_pk_bf16_f32 v182, v182, v182
    v_lshlrev_b32 v182, 16, v182
    v_mul_f32 v182, v182, v198
    v_cvt_pk_bf16_f32 v183, v183, v183
    v_lshlrev_b32 v183, 16, v183
    v_cvt_pk_bf16_f32 v199, v199, v199
    v_lshlrev_b32 v199, 16, v199
    v_mul_f32 v183, 0xbfb8aa3b, v183
    v_exp_f32 v183, v183
    s_nop 0
    v_add_f32 v183, 1.0, v183
    v_rcp_f32 v183, v183
    s_nop 0
    v_cvt_pk_bf16_f32 v183, v183, v183
    v_lshlrev_b32 v183, 16, v183
    v_mul_f32 v183, v183, v199
    v_cvt_pk_bf16_f32 v184, v184, v184
    v_lshlrev_b32 v184, 16, v184
    v_cvt_pk_bf16_f32 v200, v200, v200
    v_lshlrev_b32 v200, 16, v200
    v_mul_f32 v184, 0xbfb8aa3b, v184
    v_exp_f32 v184, v184
    s_nop 0
    v_add_f32 v184, 1.0, v184
    v_rcp_f32 v184, v184
    s_nop 0
    v_cvt_pk_bf16_f32 v184, v184, v184
    v_lshlrev_b32 v184, 16, v184
    v_mul_f32 v184, v184, v200
    v_cvt_pk_bf16_f32 v185, v185, v185
    v_lshlrev_b32 v185, 16, v185
    v_cvt_pk_bf16_f32 v201, v201, v201
    v_lshlrev_b32 v201, 16, v201
    v_mul_f32 v185, 0xbfb8aa3b, v185
    v_exp_f32 v185, v185
    s_nop 0
    v_add_f32 v185, 1.0, v185
    v_rcp_f32 v185, v185
    s_nop 0
    v_cvt_pk_bf16_f32 v185, v185, v185
    v_lshlrev_b32 v185, 16, v185
    v_mul_f32 v185, v185, v201
    v_cvt_pk_bf16_f32 v186, v186, v186
    v_lshlrev_b32 v186, 16, v186
    v_cvt_pk_bf16_f32 v202, v202, v202
    v_lshlrev_b32 v202, 16, v202
    v_mul_f32 v186, 0xbfb8aa3b, v186
    v_exp_f32 v186, v186
    s_nop 0
    v_add_f32 v186, 1.0, v186
    v_rcp_f32 v186, v186
    s_nop 0
    v_cvt_pk_bf16_f32 v186, v186, v186
    v_lshlrev_b32 v186, 16, v186
    v_mul_f32 v186, v186, v202
    v_cvt_pk_bf16_f32 v187, v187, v187
    v_lshlrev_b32 v187, 16, v187
    v_cvt_pk_bf16_f32 v203, v203, v203
    v_lshlrev_b32 v203, 16, v203
    v_mul_f32 v187, 0xbfb8aa3b, v187
    v_exp_f32 v187, v187
    s_nop 0
    v_add_f32 v187, 1.0, v187
    v_rcp_f32 v187, v187
    s_nop 0
    v_cvt_pk_bf16_f32 v187, v187, v187
    v_lshlrev_b32 v187, 16, v187
    v_mul_f32 v187, v187, v203
    v_cvt_pk_bf16_f32 v188, v188, v188
    v_lshlrev_b32 v188, 16, v188
    v_cvt_pk_bf16_f32 v204, v204, v204
    v_lshlrev_b32 v204, 16, v204
    v_mul_f32 v188, 0xbfb8aa3b, v188
    v_exp_f32 v188, v188
    s_nop 0
    v_add_f32 v188, 1.0, v188
    v_rcp_f32 v188, v188
    s_nop 0
    v_cvt_pk_bf16_f32 v188, v188, v188
    v_lshlrev_b32 v188, 16, v188
    v_mul_f32 v188, v188, v204
    v_cvt_pk_bf16_f32 v189, v189, v189
    v_lshlrev_b32 v189, 16, v189
    v_cvt_pk_bf16_f32 v205, v205, v205
    v_lshlrev_b32 v205, 16, v205
    v_mul_f32 v189, 0xbfb8aa3b, v189
    v_exp_f32 v189, v189
    s_nop 0
    v_add_f32 v189, 1.0, v189
    v_rcp_f32 v189, v189
    s_nop 0
    v_cvt_pk_bf16_f32 v189, v189, v189
    v_lshlrev_b32 v189, 16, v189
    v_mul_f32 v189, v189, v205
    v_cvt_pk_bf16_f32 v190, v190, v190
    v_lshlrev_b32 v190, 16, v190
    v_cvt_pk_bf16_f32 v206, v206, v206
    v_lshlrev_b32 v206, 16, v206
    v_mul_f32 v190, 0xbfb8aa3b, v190
    v_exp_f32 v190, v190
    s_nop 0
    v_add_f32 v190, 1.0, v190
    v_rcp_f32 v190, v190
    s_nop 0
    v_cvt_pk_bf16_f32 v190, v190, v190
    v_lshlrev_b32 v190, 16, v190
    v_mul_f32 v190, v190, v206
    v_cvt_pk_bf16_f32 v191, v191, v191
    v_lshlrev_b32 v191, 16, v191
    v_cvt_pk_bf16_f32 v207, v207, v207
    v_lshlrev_b32 v207, 16, v207
    v_mul_f32 v191, 0xbfb8aa3b, v191
    v_exp_f32 v191, v191
    s_nop 0
    v_add_f32 v191, 1.0, v191
    v_rcp_f32 v191, v191
    s_nop 0
    v_cvt_pk_bf16_f32 v191, v191, v191
    v_lshlrev_b32 v191, 16, v191
    v_mul_f32 v191, v191, v207
    v_cvt_pk_bf16_f32 v14, v176, v177
    v_cvt_pk_bf16_f32 v15, v178, v179
    buffer_store_dwordx2 v[14:15], v12, s[16:19], s40 offen offset:0
    s_nop 1
    v_cvt_pk_bf16_f32 v14, v180, v181
    v_cvt_pk_bf16_f32 v15, v182, v183
    buffer_store_dwordx2 v[14:15], v12, s[16:19], s40 offen offset:512
    s_nop 1
    v_cvt_pk_bf16_f32 v14, v184, v185
    v_cvt_pk_bf16_f32 v15, v186, v187
    buffer_store_dwordx2 v[14:15], v12, s[16:19], s40 offen offset:1024
    s_nop 1
    v_cvt_pk_bf16_f32 v14, v188, v189
    v_cvt_pk_bf16_f32 v15, v190, v191
    buffer_store_dwordx2 v[14:15], v12, s[16:19], s40 offen offset:1536
    s_nop 1
k2_kernel_end:
    s_endpgm
.globl k3_kernel
.p2align 8
.type k3_kernel,@function
k3_kernel:
    s_cmp_ge_u32 s2, 320
    s_cbranch_scc1 k3_kernel_end
    s_load_dwordx2 s[4:5], s[0:1], 96
    s_load_dwordx2 s[6:7], s[0:1], 80
    s_lshr_b32 s3, s2, 3
    s_mul_hi_u32 s24, s3, 429496730
    s_mul_i32 s25, s24, 10
    s_sub_u32 s25, s3, s25
    s_and_b32 s3, s2, 7
    s_lshl_b32 s3, s3, 2
    s_add_u32 s24, s24, s3
    v_and_b32 v9, 63, v0
    v_lshlrev_b32 v9, 4, v9
    v_lshrrev_b32 v8, 6, v0
    s_nop 1
    v_readfirstlane_b32 s26, v8
    s_waitcnt lgkmcnt(0)
    s_add_u32 s8, s4, 23068672
    s_addc_u32 s9, s5, 0
    s_and_b32 s9, s9, 0xffff
    s_mov_b32 s10, 7159808
    s_mov_b32 s11, 0x00020000
    s_add_u32 s12, s4, 4718592
    s_addc_u32 s13, s5, 0
    s_and_b32 s13, s13, 0xffff
    s_mov_b32 s14, 2237440
    s_mov_b32 s15, 0x00020000
    s_add_u32 s16, s4, 13631488
    s_addc_u32 s17, s5, 0
    s_and_b32 s17, s17, 0xffff
    s_mov_b32 s18, 2621440
    s_mov_b32 s19, 0x00020000
    s_add_u32 s20, s4, 10485760
    s_addc_u32 s21, s5, 0
    s_and_b32 s21, s21, 0xffff
    s_mov_b32 s22, 2621440
    s_mov_b32 s23, 0x00020000
    s_lshl_b32 s27, s24, 1
    s_add_u32 s27, s27, 0
    s_mul_i32 s27, s27, 111872
    v_add_u32 v1, s27, v9
    s_lshl_b32 s27, s24, 1
    s_add_u32 s27, s27, 1
    s_mul_i32 s27, s27, 111872
    v_add_u32 v2, s27, v9
    s_mul_i32 s27, s25, 2
    s_add_u32 s27, s27, 0
    s_mul_i32 s27, s27, 111872
    v_add_u32 v3, s27, v9
    s_mul_i32 s27, s25, 2
    s_add_u32 s27, s27, 1
    s_mul_i32 s27, s27, 111872
    v_add_u32 v4, s27, v9
    v_mov_b32 v64, 0
    v_mov_b32 v65, 0
    v_mov_b32 v66, 0
    v_mov_b32 v67, 0
    v_mov_b32 v68, 0
    v_mov_b32 v69, 0
    v_mov_b32 v70, 0
    v_mov_b32 v71, 0
    v_mov_b32 v72, 0
    v_mov_b32 v73, 0
    v_mov_b32 v74, 0
    v_mov_b32 v75, 0
    v_mov_b32 v76, 0
    v_mov_b32 v77, 0
    v_mov_b32 v78, 0
    v_mov_b32 v79, 0
    v_mov_b32 v80, 0
    v_mov_b32 v81, 0
    v_mov_b32 v82, 0
    v_mov_b32 v83, 0
    v_mov_b32 v84, 0
    v_mov_b32 v85, 0
    v_mov_b32 v86, 0
    v_mov_b32 v87, 0
    v_mov_b32 v88, 0
    v_mov_b32 v89, 0
    v_mov_b32 v90, 0
    v_mov_b32 v91, 0
    v_mov_b32 v92, 0
    v_mov_b32 v93, 0
    v_mov_b32 v94, 0
    v_mov_b32 v95, 0
    v_mov_b32 v96, 0
    v_mov_b32 v97, 0
    v_mov_b32 v98, 0
    v_mov_b32 v99, 0
    v_mov_b32 v100, 0
    v_mov_b32 v101, 0
    v_mov_b32 v102, 0
    v_mov_b32 v103, 0
    v_mov_b32 v104, 0
    v_mov_b32 v105, 0
    v_mov_b32 v106, 0
    v_mov_b32 v107, 0
    v_mov_b32 v108, 0
    v_mov_b32 v109, 0
    v_mov_b32 v110, 0
    v_mov_b32 v111, 0
    v_mov_b32 v112, 0
    v_mov_b32 v113, 0
    v_mov_b32 v114, 0
    v_mov_b32 v115, 0
    v_mov_b32 v116, 0
    v_mov_b32 v117, 0
    v_mov_b32 v118, 0
    v_mov_b32 v119, 0
    v_mov_b32 v120, 0
    v_mov_b32 v121, 0
    v_mov_b32 v122, 0
    v_mov_b32 v123, 0
    v_mov_b32 v124, 0
    v_mov_b32 v125, 0
    v_mov_b32 v126, 0
    v_mov_b32 v127, 0
    s_mul_i32 s33, s26, 27648
    buffer_load_dwordx4 v[16:19], v1, s[8:11], s33 offen
    buffer_load_dwordx4 v[20:23], v2, s[8:11], s33 offen
    buffer_load_dwordx4 v[24:27], v3, s[12:15], s33 offen
    buffer_load_dwordx4 v[28:31], v4, s[12:15], s33 offen
    s_add_u32 s33, s33, 1024
    buffer_load_dwordx4 v[32:35], v1, s[8:11], s33 offen
    buffer_load_dwordx4 v[36:39], v2, s[8:11], s33 offen
    buffer_load_dwordx4 v[40:43], v3, s[12:15], s33 offen
    buffer_load_dwordx4 v[44:47], v4, s[12:15], s33 offen
    s_add_u32 s33, s33, 1024
    buffer_load_dwordx4 v[48:51], v1, s[8:11], s33 offen
    buffer_load_dwordx4 v[52:55], v2, s[8:11], s33 offen
    buffer_load_dwordx4 v[56:59], v3, s[12:15], s33 offen
    buffer_load_dwordx4 v[60:63], v4, s[12:15], s33 offen
    s_add_u32 s33, s33, 1024
    s_mov_b32 s36, 0
k3_kernel_loop:
    s_waitcnt vmcnt(8)
    v_mfma_f32_32x32x16_bf16 v[64:79], v[24:27], v[16:19], v[64:79]
    v_mfma_f32_32x32x16_bf16 v[80:95], v[28:31], v[16:19], v[80:95]
    v_mfma_f32_32x32x16_bf16 v[96:111], v[24:27], v[20:23], v[96:111]
    v_mfma_f32_32x32x16_bf16 v[112:127], v[28:31], v[20:23], v[112:127]
    buffer_load_dwordx4 v[16:19], v1, s[8:11], s33 offen
    buffer_load_dwordx4 v[20:23], v2, s[8:11], s33 offen
    buffer_load_dwordx4 v[24:27], v3, s[12:15], s33 offen
    buffer_load_dwordx4 v[28:31], v4, s[12:15], s33 offen
    s_add_u32 s33, s33, 1024
    s_waitcnt vmcnt(8)
    v_mfma_f32_32x32x16_bf16 v[64:79], v[40:43], v[32:35], v[64:79]
    v_mfma_f32_32x32x16_bf16 v[80:95], v[44:47], v[32:35], v[80:95]
    v_mfma_f32_32x32x16_bf16 v[96:111], v[40:43], v[36:39], v[96:111]
    v_mfma_f32_32x32x16_bf16 v[112:127], v[44:47], v[36:39], v[112:127]
    buffer_load_dwordx4 v[32:35], v1, s[8:11], s33 offen
    buffer_load_dwordx4 v[36:39], v2, s[8:11], s33 offen
    buffer_load_dwordx4 v[40:43], v3, s[12:15], s33 offen
    buffer_load_dwordx4 v[44:47], v4, s[12:15], s33 offen
    s_add_u32 s33, s33, 1024
    s_waitcnt vmcnt(8)
    v_mfma_f32_32x32x16_bf16 v[64:79], v[56:59], v[48:51], v[64:79]
    v_mfma_f32_32x32x16_bf16 v[80:95], v[60:63], v[48:51], v[80:95]
    v_mfma_f32_32x32x16_bf16 v[96:111], v[56:59], v[52:55], v[96:111]
    v_mfma_f32_32x32x16_bf16 v[112:127], v[60:63], v[52:55], v[112:127]
    buffer_load_dwordx4 v[48:51], v1, s[8:11], s33 offen
    buffer_load_dwordx4 v[52:55], v2, s[8:11], s33 offen
    buffer_load_dwordx4 v[56:59], v3, s[12:15], s33 offen
    buffer_load_dwordx4 v[60:63], v4, s[12:15], s33 offen
    s_add_u32 s33, s33, 1024
    s_add_u32 s36, s36, 1
    s_cmp_lt_u32 s36, 9
    s_cbranch_scc1 k3_kernel_loop
    s_nop 15
    v_and_b32 v10, 31, v0
    v_bfe_u32 v11, v0, 5, 1
    s_waitcnt vmcnt(0)
    s_lshl_b32 s40, s26, 14
    v_add_u32 v8, s40, v9
    ds_write_b128 v8, v[64:67] offset:0
    ds_write_b128 v8, v[68:71] offset:1024
    ds_write_b128 v8, v[72:75] offset:2048
    ds_write_b128 v8, v[76:79] offset:3072
    ds_write_b128 v8, v[80:83] offset:4096
    ds_write_b128 v8, v[84:87] offset:5120
    ds_write_b128 v8, v[88:91] offset:6144
    ds_write_b128 v8, v[92:95] offset:7168
    ds_write_b128 v8, v[96:99] offset:8192
    ds_write_b128 v8, v[100:103] offset:9216
    ds_write_b128 v8, v[104:107] offset:10240
    ds_write_b128 v8, v[108:111] offset:11264
    ds_write_b128 v8, v[112:115] offset:12288
    ds_write_b128 v8, v[116:119] offset:13312
    ds_write_b128 v8, v[120:123] offset:14336
    ds_write_b128 v8, v[124:127] offset:15360
    s_lshr_b32 s30, s26, 1
    s_and_b32 s31, s26, 1
    s_lshl_b32 s40, s24, 6
    s_lshl_b32 s41, s30, 5
    s_add_u32 s40, s40, s41
    v_add_u32 v12, s40, v10
    v_mul_u32_u24 v12, 1280, v12
    s_lshl_b32 s40, s25, 7
    s_lshl_b32 s41, s31, 6
    s_add_u32 s40, s40, s41
    v_lshl_add_u32 v13, v11, 3, s40
    v_add_u32 v12, v12, v13
    buffer_load_dwordx2 v[16:17], v12, s[20:23], 0 offen offset:0
    buffer_load_dwordx2 v[18:19], v12, s[20:23], 0 offen offset:16
    buffer_load_dwordx2 v[20:21], v12, s[20:23], 0 offen offset:32
    buffer_load_dwordx2 v[22:23], v12, s[20:23], 0 offen offset:48
    s_lshl_b32 s40, s26, 12
    v_add_u32 v8, s40, v9
    s_waitcnt lgkmcnt(0)
    s_barrier
    ds_read_b128 v[64:67], v8 offset:0
    ds_read_b128 v[68:71], v8 offset:1024
    ds_read_b128 v[72:75], v8 offset:2048
    ds_read_b128 v[76:79], v8 offset:3072
    ds_read_b128 v[80:83], v8 offset:16384
    ds_read_b128 v[84:87], v8 offset:17408
    ds_read_b128 v[88:91], v8 offset:18432
    ds_read_b128 v[92:95], v8 offset:19456
    ds_read_b128 v[96:99], v8 offset:32768
    ds_read_b128 v[100:103], v8 offset:33792
    ds_read_b128 v[104:107], v8 offset:34816
    ds_read_b128 v[108:111], v8 offset:35840
    ds_read_b128 v[112:115], v8 offset:49152
    ds_read_b128 v[116:119], v8 offset:50176
    ds_read_b128 v[120:123], v8 offset:51200
    ds_read_b128 v[124:127], v8 offset:52224
    s_waitcnt lgkmcnt(0) vmcnt(0)
    v_add_f32 v64, v64, v80
    v_add_f32 v96, v96, v112
    v_add_f32 v64, v64, v96
    v_add_f32 v65, v65, v81
    v_add_f32 v97, v97, v113
    v_add_f32 v65, v65, v97
    v_add_f32 v66, v66, v82
    v_add_f32 v98, v98, v114
    v_add_f32 v66, v66, v98
    v_add_f32 v67, v67, v83
    v_add_f32 v99, v99, v115
    v_add_f32 v67, v67, v99
    v_add_f32 v68, v68, v84
    v_add_f32 v100, v100, v116
    v_add_f32 v68, v68, v100
    v_add_f32 v69, v69, v85
    v_add_f32 v101, v101, v117
    v_add_f32 v69, v69, v101
    v_add_f32 v70, v70, v86
    v_add_f32 v102, v102, v118
    v_add_f32 v70, v70, v102
    v_add_f32 v71, v71, v87
    v_add_f32 v103, v103, v119
    v_add_f32 v71, v71, v103
    v_add_f32 v72, v72, v88
    v_add_f32 v104, v104, v120
    v_add_f32 v72, v72, v104
    v_add_f32 v73, v73, v89
    v_add_f32 v105, v105, v121
    v_add_f32 v73, v73, v105
    v_add_f32 v74, v74, v90
    v_add_f32 v106, v106, v122
    v_add_f32 v74, v74, v106
    v_add_f32 v75, v75, v91
    v_add_f32 v107, v107, v123
    v_add_f32 v75, v75, v107
    v_add_f32 v76, v76, v92
    v_add_f32 v108, v108, v124
    v_add_f32 v76, v76, v108
    v_add_f32 v77, v77, v93
    v_add_f32 v109, v109, v125
    v_add_f32 v77, v77, v109
    v_add_f32 v78, v78, v94
    v_add_f32 v110, v110, v126
    v_add_f32 v78, v78, v110
    v_add_f32 v79, v79, v95
    v_add_f32 v111, v111, v127
    v_add_f32 v79, v79, v111
    v_cvt_pk_bf16_f32 v64, v64, v64
    v_lshlrev_b32 v64, 16, v64
    v_lshlrev_b32 v14, 16, v16
    v_add_f32 v64, v64, v14
    v_cvt_pk_bf16_f32 v65, v65, v65
    v_lshlrev_b32 v65, 16, v65
    v_and_b32 v14, 0xffff0000, v16
    v_add_f32 v65, v65, v14
    v_cvt_pk_bf16_f32 v66, v66, v66
    v_lshlrev_b32 v66, 16, v66
    v_lshlrev_b32 v14, 16, v17
    v_add_f32 v66, v66, v14
    v_cvt_pk_bf16_f32 v67, v67, v67
    v_lshlrev_b32 v67, 16, v67
    v_and_b32 v14, 0xffff0000, v17
    v_add_f32 v67, v67, v14
    v_cvt_pk_bf16_f32 v24, v64, v65
    v_cvt_pk_bf16_f32 v25, v66, v67
    v_cvt_pk_bf16_f32 v68, v68, v68
    v_lshlrev_b32 v68, 16, v68
    v_lshlrev_b32 v14, 16, v18
    v_add_f32 v68, v68, v14
    v_cvt_pk_bf16_f32 v69, v69, v69
    v_lshlrev_b32 v69, 16, v69
    v_and_b32 v14, 0xffff0000, v18
    v_add_f32 v69, v69, v14
    v_cvt_pk_bf16_f32 v70, v70, v70
    v_lshlrev_b32 v70, 16, v70
    v_lshlrev_b32 v14, 16, v19
    v_add_f32 v70, v70, v14
    v_cvt_pk_bf16_f32 v71, v71, v71
    v_lshlrev_b32 v71, 16, v71
    v_and_b32 v14, 0xffff0000, v19
    v_add_f32 v71, v71, v14
    v_cvt_pk_bf16_f32 v26, v68, v69
    v_cvt_pk_bf16_f32 v27, v70, v71
    v_cvt_pk_bf16_f32 v72, v72, v72
    v_lshlrev_b32 v72, 16, v72
    v_lshlrev_b32 v14, 16, v20
    v_add_f32 v72, v72, v14
    v_cvt_pk_bf16_f32 v73, v73, v73
    v_lshlrev_b32 v73, 16, v73
    v_and_b32 v14, 0xffff0000, v20
    v_add_f32 v73, v73, v14
    v_cvt_pk_bf16_f32 v74, v74, v74
    v_lshlrev_b32 v74, 16, v74
    v_lshlrev_b32 v14, 16, v21
    v_add_f32 v74, v74, v14
    v_cvt_pk_bf16_f32 v75, v75, v75
    v_lshlrev_b32 v75, 16, v75
    v_and_b32 v14, 0xffff0000, v21
    v_add_f32 v75, v75, v14
    v_cvt_pk_bf16_f32 v28, v72, v73
    v_cvt_pk_bf16_f32 v29, v74, v75
    v_cvt_pk_bf16_f32 v76, v76, v76
    v_lshlrev_b32 v76, 16, v76
    v_lshlrev_b32 v14, 16, v22
    v_add_f32 v76, v76, v14
    v_cvt_pk_bf16_f32 v77, v77, v77
    v_lshlrev_b32 v77, 16, v77
    v_and_b32 v14, 0xffff0000, v22
    v_add_f32 v77, v77, v14
    v_cvt_pk_bf16_f32 v78, v78, v78
    v_lshlrev_b32 v78, 16, v78
    v_lshlrev_b32 v14, 16, v23
    v_add_f32 v78, v78, v14
    v_cvt_pk_bf16_f32 v79, v79, v79
    v_lshlrev_b32 v79, 16, v79
    v_and_b32 v14, 0xffff0000, v23
    v_add_f32 v79, v79, v14
    v_cvt_pk_bf16_f32 v30, v76, v77
    v_cvt_pk_bf16_f32 v31, v78, v79
    buffer_store_dwordx2 v[24:25], v12, s[16:19], 0 offen offset:0
    buffer_store_dwordx2 v[26:27], v12, s[16:19], 0 offen offset:16
    buffer_store_dwordx2 v[28:29], v12, s[16:19], 0 offen offset:32
    buffer_store_dwordx2 v[30:31], v12, s[16:19], 0 offen offset:48
k3_kernel_end:
    s_endpgm
.globl k4_kernel
.p2align 8
.type k4_kernel,@function
k4_kernel:
    s_cmp_ge_u32 s2, 512
    s_cbranch_scc1 k4_kernel_end
    s_load_dwordx2 s[4:5], s[0:1], 96
    s_load_dwordx2 s[6:7], s[0:1], 96
    v_lshrrev_b32 v1, 4, v0
    v_and_b32 v2, 15, v0
    v_lshl_add_u32 v1, s2, 2, v1
    v_mul_u32_u24 v3, 1280, v1
    v_lshl_add_u32 v3, v2, 4, v3
    s_waitcnt lgkmcnt(0)
    s_add_u32 s8, s4, 13631488
    s_addc_u32 s9, s5, 0
    s_and_b32 s9, s9, 0xffff
    s_mov_b32 s10, 2621440
    s_mov_b32 s11, 0x00020000
    s_add_u32 s12, s6, 7340032
    s_addc_u32 s13, s7, 0
    s_and_b32 s13, s13, 0xffff
    s_mov_b32 s14, 2621440
    s_mov_b32 s15, 0x00020000
    s_add_u32 s16, s6, 16777216
    s_addc_u32 s17, s7, 0
    s_and_b32 s17, s17, 0xffff
    s_mov_b32 s18, 2621440
    s_mov_b32 s19, 0x00020000
    s_add_u32 s20, s6, 19922944
    s_addc_u32 s21, s7, 0
    s_and_b32 s21, s21, 0xffff
    s_mov_b32 s22, 2703360
    s_mov_b32 s23, 0x00020000
    buffer_load_dwordx4 v[140:143], v3, s[8:11], 0 offen offset:0
    buffer_load_dwordx4 v[144:147], v3, s[8:11], 0 offen offset:256
    buffer_load_dwordx4 v[148:151], v3, s[8:11], 0 offen offset:512
    buffer_load_dwordx4 v[152:155], v3, s[8:11], 0 offen offset:768
    buffer_load_dwordx4 v[156:159], v3, s[8:11], 0 offen offset:1024
    v_lshlrev_b32 v6, 15, v2
    v_lshl_add_u32 v6, v1, 3, v6
    buffer_load_dwordx2 v[160:161], v6, s[12:15], 0 offen
    v_add_u32 v6, 16384, v6
    buffer_load_dwordx2 v[162:163], v6, s[12:15], 0 offen
    v_add_u32 v6, 507904, v6
    buffer_load_dwordx2 v[164:165], v6, s[12:15], 0 offen
    v_add_u32 v6, 16384, v6
    buffer_load_dwordx2 v[166:167], v6, s[12:15], 0 offen
    v_add_u32 v6, 507904, v6
    buffer_load_dwordx2 v[168:169], v6, s[12:15], 0 offen
    v_add_u32 v6, 16384, v6
    buffer_load_dwordx2 v[170:171], v6, s[12:15], 0 offen
    v_add_u32 v6, 507904, v6
    buffer_load_dwordx2 v[172:173], v6, s[12:15], 0 offen
    v_add_u32 v6, 16384, v6
    buffer_load_dwordx2 v[174:175], v6, s[12:15], 0 offen
    v_add_u32 v6, 507904, v6
    buffer_load_dwordx2 v[176:177], v6, s[12:15], 0 offen
    v_add_u32 v6, 16384, v6
    buffer_load_dwordx2 v[178:179], v6, s[12:15], 0 offen
    v_add_u32 v6, 507904, v6
    s_waitcnt vmcnt(10)
    v_lshlrev_b32 v10, 16, v140
    v_and_b32 v11, 0xffff0000, v140
    v_lshlrev_b32 v12, 16, v141
    v_and_b32 v13, 0xffff0000, v141
    v_lshlrev_b32 v14, 16, v142
    v_and_b32 v15, 0xffff0000, v142
    v_lshlrev_b32 v16, 16, v143
    v_and_b32 v17, 0xffff0000, v143
    v_lshlrev_b32 v18, 16, v144
    v_and_b32 v19, 0xffff0000, v144
    v_lshlrev_b32 v20, 16, v145
    v_and_b32 v21, 0xffff0000, v145
    v_lshlrev_b32 v22, 16, v146
    v_and_b32 v23, 0xffff0000, v146
    v_lshlrev_b32 v24, 16, v147
    v_and_b32 v25, 0xffff0000, v147
    v_lshlrev_b32 v26, 16, v148
    v_and_b32 v27, 0xffff0000, v148
    v_lshlrev_b32 v28, 16, v149
    v_and_b32 v29, 0xffff0000, v149
    v_lshlrev_b32 v30, 16, v150
    v_and_b32 v31, 0xffff0000, v150
    v_lshlrev_b32 v32, 16, v151
    v_and_b32 v33, 0xffff0000, v151
    v_lshlrev_b32 v34, 16, v152
    v_and_b32 v35, 0xffff0000, v152
    v_lshlrev_b32 v36, 16, v153
    v_and_b32 v37, 0xffff0000, v153
    v_lshlrev_b32 v38, 16, v154
    v_and_b32 v39, 0xffff0000, v154
    v_lshlrev_b32 v40, 16, v155
    v_and_b32 v41, 0xffff0000, v155
    v_lshlrev_b32 v42, 16, v156
    v_and_b32 v43, 0xffff0000, v156
    v_lshlrev_b32 v44, 16, v157
    v_and_b32 v45, 0xffff0000, v157
    v_lshlrev_b32 v46, 16, v158
    v_and_b32 v47, 0xffff0000, v158
    v_lshlrev_b32 v48, 16, v159
    v_and_b32 v49, 0xffff0000, v159
    v_mov_b32 v90, v10
    v_add_f32 v90, v90, v11
    v_add_f32 v90, v90, v12
    v_add_f32 v90, v90, v13
    v_add_f32 v90, v90, v14
    v_add_f32 v90, v90, v15
    v_add_f32 v90, v90, v16
    v_add_f32 v90, v90, v17
    v_add_f32 v90, v90, v18
    v_add_f32 v90, v90, v19
    v_add_f32 v90, v90, v20
    v_add_f32 v90, v90, v21
    v_add_f32 v90, v90, v22
    v_add_f32 v90, v90, v23
    v_add_f32 v90, v90, v24
    v_add_f32 v90, v90, v25
    v_add_f32 v90, v90, v26
    v_add_f32 v90, v90, v27
    v_add_f32 v90, v90, v28
    v_add_f32 v90, v90, v29
    v_add_f32 v90, v90, v30
    v_add_f32 v90, v90, v31
    v_add_f32 v90, v90, v32
    v_add_f32 v90, v90, v33
    v_add_f32 v90, v90, v34
    v_add_f32 v90, v90, v35
    v_add_f32 v90, v90, v36
    v_add_f32 v90, v90, v37
    v_add_f32 v90, v90, v38
    v_add_f32 v90, v90, v39
    v_add_f32 v90, v90, v40
    v_add_f32 v90, v90, v41
    v_add_f32 v90, v90, v42
    v_add_f32 v90, v90, v43
    v_add_f32 v90, v90, v44
    v_add_f32 v90, v90, v45
    v_add_f32 v90, v90, v46
    v_add_f32 v90, v90, v47
    v_add_f32 v90, v90, v48
    v_add_f32 v90, v90, v49
    s_nop 1
    v_add_f32_dpp v90, v90, v90 row_ror:8 row_mask:0xf bank_mask:0xf
    s_nop 1
    v_add_f32_dpp v90, v90, v90 row_ror:4 row_mask:0xf bank_mask:0xf
    s_nop 1
    v_add_f32_dpp v90, v90, v90 row_ror:2 row_mask:0xf bank_mask:0xf
    s_nop 1
    v_add_f32_dpp v90, v90, v90 row_ror:1 row_mask:0xf bank_mask:0xf
    v_mul_f32 v90, 0.0015625, v90
    v_mov_b32 v91, 0
    v_sub_f32 v92, v10, v90
    v_fmac_f32 v91, v92, v92
    v_sub_f32 v92, v11, v90
    v_fmac_f32 v91, v92, v92
    v_sub_f32 v92, v12, v90
    v_fmac_f32 v91, v92, v92
    v_sub_f32 v92, v13, v90
    v_fmac_f32 v91, v92, v92
    v_sub_f32 v92, v14, v90
    v_fmac_f32 v91, v92, v92
    v_sub_f32 v92, v15, v90
    v_fmac_f32 v91, v92, v92
    v_sub_f32 v92, v16, v90
    v_fmac_f32 v91, v92, v92
    v_sub_f32 v92, v17, v90
    v_fmac_f32 v91, v92, v92
    v_sub_f32 v92, v18, v90
    v_fmac_f32 v91, v92, v92
    v_sub_f32 v92, v19, v90
    v_fmac_f32 v91, v92, v92
    v_sub_f32 v92, v20, v90
    v_fmac_f32 v91, v92, v92
    v_sub_f32 v92, v21, v90
    v_fmac_f32 v91, v92, v92
    v_sub_f32 v92, v22, v90
    v_fmac_f32 v91, v92, v92
    v_sub_f32 v92, v23, v90
    v_fmac_f32 v91, v92, v92
    v_sub_f32 v92, v24, v90
    v_fmac_f32 v91, v92, v92
    v_sub_f32 v92, v25, v90
    v_fmac_f32 v91, v92, v92
    v_sub_f32 v92, v26, v90
    v_fmac_f32 v91, v92, v92
    v_sub_f32 v92, v27, v90
    v_fmac_f32 v91, v92, v92
    v_sub_f32 v92, v28, v90
    v_fmac_f32 v91, v92, v92
    v_sub_f32 v92, v29, v90
    v_fmac_f32 v91, v92, v92
    v_sub_f32 v92, v30, v90
    v_fmac_f32 v91, v92, v92
    v_sub_f32 v92, v31, v90
    v_fmac_f32 v91, v92, v92
    v_sub_f32 v92, v32, v90
    v_fmac_f32 v91, v92, v92
    v_sub_f32 v92, v33, v90
    v_fmac_f32 v91, v92, v92
    v_sub_f32 v92, v34, v90
    v_fmac_f32 v91, v92, v92
    v_sub_f32 v92, v35, v90
    v_fmac_f32 v91, v92, v92
    v_sub_f32 v92, v36, v90
    v_fmac_f32 v91, v92, v92
    v_sub_f32 v92, v37, v90
    v_fmac_f32 v91, v92, v92
    v_sub_f32 v92, v38, v90
    v_fmac_f32 v91, v92, v92
    v_sub_f32 v92, v39, v90
    v_fmac_f32 v91, v92, v92
    v_sub_f32 v92, v40, v90
    v_fmac_f32 v91, v92, v92
    v_sub_f32 v92, v41, v90
    v_fmac_f32 v91, v92, v92
    v_sub_f32 v92, v42, v90
    v_fmac_f32 v91, v92, v92
    v_sub_f32 v92, v43, v90
    v_fmac_f32 v91, v92, v92
    v_sub_f32 v92, v44, v90
    v_fmac_f32 v91, v92, v92
    v_sub_f32 v92, v45, v90
    v_fmac_f32 v91, v92, v92
    v_sub_f32 v92, v46, v90
    v_fmac_f32 v91, v92, v92
    v_sub_f32 v92, v47, v90
    v_fmac_f32 v91, v92, v92
    v_sub_f32 v92, v48, v90
    v_fmac_f32 v91, v92, v92
    v_sub_f32 v92, v49, v90
    v_fmac_f32 v91, v92, v92
    s_nop 1
    v_add_f32_dpp v91, v91, v91 row_ror:8 row_mask:0xf bank_mask:0xf
    s_nop 1
    v_add_f32_dpp v91, v91, v91 row_ror:4 row_mask:0xf bank_mask:0xf
    s_nop 1
    v_add_f32_dpp v91, v91, v91 row_ror:2 row_mask:0xf bank_mask:0xf
    s_nop 1
    v_add_f32_dpp v91, v91, v91 row_ror:1 row_mask:0xf bank_mask:0xf
    v_mul_f32 v91, 0.0015625, v91
    v_cvt_pk_bf16_f32 v91, v91, v91
    v_lshlrev_b32 v91, 16, v91
    v_add_f32 v91, 0x3727c5ac, v91
    v_cvt_pk_bf16_f32 v91, v91, v91
    v_lshlrev_b32 v91, 16, v91
    v_sqrt_f32 v91, v91
    s_nop 0
    v_cvt_pk_bf16_f32 v91, v91, v91
    v_lshlrev_b32 v91, 16, v91
    v_rcp_f32 v91, v91
    v_cvt_pk_bf16_f32 v90, v90, v90
    v_lshlrev_b32 v90, 16, v90
    v_sub_f32 v100, v10, v90
    v_cvt_pk_bf16_f32 v100, v100, v100
    v_lshlrev_b32 v100, 16, v100
    v_mul_f32 v100, v100, v91
    v_cvt_pk_bf16_f32 v100, v100, v100
    v_lshlrev_b32 v100, 16, v100
    v_sub_f32 v101, v11, v90
    v_cvt_pk_bf16_f32 v101, v101, v101
    v_lshlrev_b32 v101, 16, v101
    v_mul_f32 v101, v101, v91
    v_cvt_pk_bf16_f32 v101, v101, v101
    v_lshlrev_b32 v101, 16, v101
    v_sub_f32 v102, v12, v90
    v_cvt_pk_bf16_f32 v102, v102, v102
    v_lshlrev_b32 v102, 16, v102
    v_mul_f32 v102, v102, v91
    v_cvt_pk_bf16_f32 v102, v102, v102
    v_lshlrev_b32 v102, 16, v102
    v_sub_f32 v103, v13, v90
    v_cvt_pk_bf16_f32 v103, v103, v103
    v_lshlrev_b32 v103, 16, v103
    v_mul_f32 v103, v103, v91
    v_cvt_pk_bf16_f32 v103, v103, v103
    v_lshlrev_b32 v103, 16, v103
    v_sub_f32 v104, v14, v90
    v_cvt_pk_bf16_f32 v104, v104, v104
    v_lshlrev_b32 v104, 16, v104
    v_mul_f32 v104, v104, v91
    v_cvt_pk_bf16_f32 v104, v104, v104
    v_lshlrev_b32 v104, 16, v104
    v_sub_f32 v105, v15, v90
    v_cvt_pk_bf16_f32 v105, v105, v105
    v_lshlrev_b32 v105, 16, v105
    v_mul_f32 v105, v105, v91
    v_cvt_pk_bf16_f32 v105, v105, v105
    v_lshlrev_b32 v105, 16, v105
    v_sub_f32 v106, v16, v90
    v_cvt_pk_bf16_f32 v106, v106, v106
    v_lshlrev_b32 v106, 16, v106
    v_mul_f32 v106, v106, v91
    v_cvt_pk_bf16_f32 v106, v106, v106
    v_lshlrev_b32 v106, 16, v106
    v_sub_f32 v107, v17, v90
    v_cvt_pk_bf16_f32 v107, v107, v107
    v_lshlrev_b32 v107, 16, v107
    v_mul_f32 v107, v107, v91
    v_cvt_pk_bf16_f32 v107, v107, v107
    v_lshlrev_b32 v107, 16, v107
    v_sub_f32 v108, v18, v90
    v_cvt_pk_bf16_f32 v108, v108, v108
    v_lshlrev_b32 v108, 16, v108
    v_mul_f32 v108, v108, v91
    v_cvt_pk_bf16_f32 v108, v108, v108
    v_lshlrev_b32 v108, 16, v108
    v_sub_f32 v109, v19, v90
    v_cvt_pk_bf16_f32 v109, v109, v109
    v_lshlrev_b32 v109, 16, v109
    v_mul_f32 v109, v109, v91
    v_cvt_pk_bf16_f32 v109, v109, v109
    v_lshlrev_b32 v109, 16, v109
    v_sub_f32 v110, v20, v90
    v_cvt_pk_bf16_f32 v110, v110, v110
    v_lshlrev_b32 v110, 16, v110
    v_mul_f32 v110, v110, v91
    v_cvt_pk_bf16_f32 v110, v110, v110
    v_lshlrev_b32 v110, 16, v110
    v_sub_f32 v111, v21, v90
    v_cvt_pk_bf16_f32 v111, v111, v111
    v_lshlrev_b32 v111, 16, v111
    v_mul_f32 v111, v111, v91
    v_cvt_pk_bf16_f32 v111, v111, v111
    v_lshlrev_b32 v111, 16, v111
    v_sub_f32 v112, v22, v90
    v_cvt_pk_bf16_f32 v112, v112, v112
    v_lshlrev_b32 v112, 16, v112
    v_mul_f32 v112, v112, v91
    v_cvt_pk_bf16_f32 v112, v112, v112
    v_lshlrev_b32 v112, 16, v112
    v_sub_f32 v113, v23, v90
    v_cvt_pk_bf16_f32 v113, v113, v113
    v_lshlrev_b32 v113, 16, v113
    v_mul_f32 v113, v113, v91
    v_cvt_pk_bf16_f32 v113, v113, v113
    v_lshlrev_b32 v113, 16, v113
    v_sub_f32 v114, v24, v90
    v_cvt_pk_bf16_f32 v114, v114, v114
    v_lshlrev_b32 v114, 16, v114
    v_mul_f32 v114, v114, v91
    v_cvt_pk_bf16_f32 v114, v114, v114
    v_lshlrev_b32 v114, 16, v114
    v_sub_f32 v115, v25, v90
    v_cvt_pk_bf16_f32 v115, v115, v115
    v_lshlrev_b32 v115, 16, v115
    v_mul_f32 v115, v115, v91
    v_cvt_pk_bf16_f32 v115, v115, v115
    v_lshlrev_b32 v115, 16, v115
    v_sub_f32 v116, v26, v90
    v_cvt_pk_bf16_f32 v116, v116, v116
    v_lshlrev_b32 v116, 16, v116
    v_mul_f32 v116, v116, v91
    v_cvt_pk_bf16_f32 v116, v116, v116
    v_lshlrev_b32 v116, 16, v116
    v_sub_f32 v117, v27, v90
    v_cvt_pk_bf16_f32 v117, v117, v117
    v_lshlrev_b32 v117, 16, v117
    v_mul_f32 v117, v117, v91
    v_cvt_pk_bf16_f32 v117, v117, v117
    v_lshlrev_b32 v117, 16, v117
    v_sub_f32 v118, v28, v90
    v_cvt_pk_bf16_f32 v118, v118, v118
    v_lshlrev_b32 v118, 16, v118
    v_mul_f32 v118, v118, v91
    v_cvt_pk_bf16_f32 v118, v118, v118
    v_lshlrev_b32 v118, 16, v118
    v_sub_f32 v119, v29, v90
    v_cvt_pk_bf16_f32 v119, v119, v119
    v_lshlrev_b32 v119, 16, v119
    v_mul_f32 v119, v119, v91
    v_cvt_pk_bf16_f32 v119, v119, v119
    v_lshlrev_b32 v119, 16, v119
    v_sub_f32 v120, v30, v90
    v_cvt_pk_bf16_f32 v120, v120, v120
    v_lshlrev_b32 v120, 16, v120
    v_mul_f32 v120, v120, v91
    v_cvt_pk_bf16_f32 v120, v120, v120
    v_lshlrev_b32 v120, 16, v120
    v_sub_f32 v121, v31, v90
    v_cvt_pk_bf16_f32 v121, v121, v121
    v_lshlrev_b32 v121, 16, v121
    v_mul_f32 v121, v121, v91
    v_cvt_pk_bf16_f32 v121, v121, v121
    v_lshlrev_b32 v121, 16, v121
    v_sub_f32 v122, v32, v90
    v_cvt_pk_bf16_f32 v122, v122, v122
    v_lshlrev_b32 v122, 16, v122
    v_mul_f32 v122, v122, v91
    v_cvt_pk_bf16_f32 v122, v122, v122
    v_lshlrev_b32 v122, 16, v122
    v_sub_f32 v123, v33, v90
    v_cvt_pk_bf16_f32 v123, v123, v123
    v_lshlrev_b32 v123, 16, v123
    v_mul_f32 v123, v123, v91
    v_cvt_pk_bf16_f32 v123, v123, v123
    v_lshlrev_b32 v123, 16, v123
    v_sub_f32 v124, v34, v90
    v_cvt_pk_bf16_f32 v124, v124, v124
    v_lshlrev_b32 v124, 16, v124
    v_mul_f32 v124, v124, v91
    v_cvt_pk_bf16_f32 v124, v124, v124
    v_lshlrev_b32 v124, 16, v124
    v_sub_f32 v125, v35, v90
    v_cvt_pk_bf16_f32 v125, v125, v125
    v_lshlrev_b32 v125, 16, v125
    v_mul_f32 v125, v125, v91
    v_cvt_pk_bf16_f32 v125, v125, v125
    v_lshlrev_b32 v125, 16, v125
    v_sub_f32 v126, v36, v90
    v_cvt_pk_bf16_f32 v126, v126, v126
    v_lshlrev_b32 v126, 16, v126
    v_mul_f32 v126, v126, v91
    v_cvt_pk_bf16_f32 v126, v126, v126
    v_lshlrev_b32 v126, 16, v126
    v_sub_f32 v127, v37, v90
    v_cvt_pk_bf16_f32 v127, v127, v127
    v_lshlrev_b32 v127, 16, v127
    v_mul_f32 v127, v127, v91
    v_cvt_pk_bf16_f32 v127, v127, v127
    v_lshlrev_b32 v127, 16, v127
    v_sub_f32 v128, v38, v90
    v_cvt_pk_bf16_f32 v128, v128, v128
    v_lshlrev_b32 v128, 16, v128
    v_mul_f32 v128, v128, v91
    v_cvt_pk_bf16_f32 v128, v128, v128
    v_lshlrev_b32 v128, 16, v128
    v_sub_f32 v129, v39, v90
    v_cvt_pk_bf16_f32 v129, v129, v129
    v_lshlrev_b32 v129, 16, v129
    v_mul_f32 v129, v129, v91
    v_cvt_pk_bf16_f32 v129, v129, v129
    v_lshlrev_b32 v129, 16, v129
    v_sub_f32 v130, v40, v90
    v_cvt_pk_bf16_f32 v130, v130, v130
    v_lshlrev_b32 v130, 16, v130
    v_mul_f32 v130, v130, v91
    v_cvt_pk_bf16_f32 v130, v130, v130
    v_lshlrev_b32 v130, 16, v130
    v_sub_f32 v131, v41, v90
    v_cvt_pk_bf16_f32 v131, v131, v131
    v_lshlrev_b32 v131, 16, v131
    v_mul_f32 v131, v131, v91
    v_cvt_pk_bf16_f32 v131, v131, v131
    v_lshlrev_b32 v131, 16, v131
    v_sub_f32 v132, v42, v90
    v_cvt_pk_bf16_f32 v132, v132, v132
    v_lshlrev_b32 v132, 16, v132
    v_mul_f32 v132, v132, v91
    v_cvt_pk_bf16_f32 v132, v132, v132
    v_lshlrev_b32 v132, 16, v132
    v_sub_f32 v133, v43, v90
    v_cvt_pk_bf16_f32 v133, v133, v133
    v_lshlrev_b32 v133, 16, v133
    v_mul_f32 v133, v133, v91
    v_cvt_pk_bf16_f32 v133, v133, v133
    v_lshlrev_b32 v133, 16, v133
    v_sub_f32 v134, v44, v90
    v_cvt_pk_bf16_f32 v134, v134, v134
    v_lshlrev_b32 v134, 16, v134
    v_mul_f32 v134, v134, v91
    v_cvt_pk_bf16_f32 v134, v134, v134
    v_lshlrev_b32 v134, 16, v134
    v_sub_f32 v135, v45, v90
    v_cvt_pk_bf16_f32 v135, v135, v135
    v_lshlrev_b32 v135, 16, v135
    v_mul_f32 v135, v135, v91
    v_cvt_pk_bf16_f32 v135, v135, v135
    v_lshlrev_b32 v135, 16, v135
    v_sub_f32 v136, v46, v90
    v_cvt_pk_bf16_f32 v136, v136, v136
    v_lshlrev_b32 v136, 16, v136
    v_mul_f32 v136, v136, v91
    v_cvt_pk_bf16_f32 v136, v136, v136
    v_lshlrev_b32 v136, 16, v136
    v_sub_f32 v137, v47, v90
    v_cvt_pk_bf16_f32 v137, v137, v137
    v_lshlrev_b32 v137, 16, v137
    v_mul_f32 v137, v137, v91
    v_cvt_pk_bf16_f32 v137, v137, v137
    v_lshlrev_b32 v137, 16, v137
    v_sub_f32 v138, v48, v90
    v_cvt_pk_bf16_f32 v138, v138, v138
    v_lshlrev_b32 v138, 16, v138
    v_mul_f32 v138, v138, v91
    v_cvt_pk_bf16_f32 v138, v138, v138
    v_lshlrev_b32 v138, 16, v138
    v_sub_f32 v139, v49, v90
    v_cvt_pk_bf16_f32 v139, v139, v139
    v_lshlrev_b32 v139, 16, v139
    v_mul_f32 v139, v139, v91
    v_cvt_pk_bf16_f32 v139, v139, v139
    v_lshlrev_b32 v139, 16, v139
    s_waitcnt vmcnt(0)
    v_lshlrev_b32 v92, 16, v160
    v_mul_f32 v92, v92, v100
    v_cvt_pk_bf16_f32 v92, v92, v92
    v_lshlrev_b32 v92, 16, v92
    v_add_f32 v10, v10, v92
    v_cvt_pk_bf16_f32 v10, v10, v10
    v_lshlrev_b32 v10, 16, v10
    v_and_b32 v92, 0xffff0000, v160
    v_mul_f32 v92, v92, v101
    v_cvt_pk_bf16_f32 v92, v92, v92
    v_lshlrev_b32 v92, 16, v92
    v_add_f32 v11, v11, v92
    v_cvt_pk_bf16_f32 v11, v11, v11
    v_lshlrev_b32 v11, 16, v11
    v_cvt_pk_bf16_f32 v140, v10, v11
    v_lshlrev_b32 v92, 16, v161
    v_mul_f32 v92, v92, v102
    v_cvt_pk_bf16_f32 v92, v92, v92
    v_lshlrev_b32 v92, 16, v92
    v_add_f32 v12, v12, v92
    v_cvt_pk_bf16_f32 v12, v12, v12
    v_lshlrev_b32 v12, 16, v12
    v_and_b32 v92, 0xffff0000, v161
    v_mul_f32 v92, v92, v103
    v_cvt_pk_bf16_f32 v92, v92, v92
    v_lshlrev_b32 v92, 16, v92
    v_add_f32 v13, v13, v92
    v_cvt_pk_bf16_f32 v13, v13, v13
    v_lshlrev_b32 v13, 16, v13
    v_cvt_pk_bf16_f32 v141, v12, v13
    v_lshlrev_b32 v92, 16, v162
    v_mul_f32 v92, v92, v104
    v_cvt_pk_bf16_f32 v92, v92, v92
    v_lshlrev_b32 v92, 16, v92
    v_add_f32 v14, v14, v92
    v_cvt_pk_bf16_f32 v14, v14, v14
    v_lshlrev_b32 v14, 16, v14
    v_and_b32 v92, 0xffff0000, v162
    v_mul_f32 v92, v92, v105
    v_cvt_pk_bf16_f32 v92, v92, v92
    v_lshlrev_b32 v92, 16, v92
    v_add_f32 v15, v15, v92
    v_cvt_pk_bf16_f32 v15, v15, v15
    v_lshlrev_b32 v15, 16, v15
    v_cvt_pk_bf16_f32 v142, v14, v15
    v_lshlrev_b32 v92, 16, v163
    v_mul_f32 v92, v92, v106
    v_cvt_pk_bf16_f32 v92, v92, v92
    v_lshlrev_b32 v92, 16, v92
    v_add_f32 v16, v16, v92
    v_cvt_pk_bf16_f32 v16, v16, v16
    v_lshlrev_b32 v16, 16, v16
    v_and_b32 v92, 0xffff0000, v163
    v_mul_f32 v92, v92, v107
    v_cvt_pk_bf16_f32 v92, v92, v92
    v_lshlrev_b32 v92, 16, v92
    v_add_f32 v17, v17, v92
    v_cvt_pk_bf16_f32 v17, v17, v17
    v_lshlrev_b32 v17, 16, v17
    v_cvt_pk_bf16_f32 v143, v16, v17
    v_lshlrev_b32 v92, 16, v164
    v_mul_f32 v92, v92, v108
    v_cvt_pk_bf16_f32 v92, v92, v92
    v_lshlrev_b32 v92, 16, v92
    v_add_f32 v18, v18, v92
    v_cvt_pk_bf16_f32 v18, v18, v18
    v_lshlrev_b32 v18, 16, v18
    v_and_b32 v92, 0xffff0000, v164
    v_mul_f32 v92, v92, v109
    v_cvt_pk_bf16_f32 v92, v92, v92
    v_lshlrev_b32 v92, 16, v92
    v_add_f32 v19, v19, v92
    v_cvt_pk_bf16_f32 v19, v19, v19
    v_lshlrev_b32 v19, 16, v19
    v_cvt_pk_bf16_f32 v144, v18, v19
    v_lshlrev_b32 v92, 16, v165
    v_mul_f32 v92, v92, v110
    v_cvt_pk_bf16_f32 v92, v92, v92
    v_lshlrev_b32 v92, 16, v92
    v_add_f32 v20, v20, v92
    v_cvt_pk_bf16_f32 v20, v20, v20
    v_lshlrev_b32 v20, 16, v20
    v_and_b32 v92, 0xffff0000, v165
    v_mul_f32 v92, v92, v111
    v_cvt_pk_bf16_f32 v92, v92, v92
    v_lshlrev_b32 v92, 16, v92
    v_add_f32 v21, v21, v92
    v_cvt_pk_bf16_f32 v21, v21, v21
    v_lshlrev_b32 v21, 16, v21
    v_cvt_pk_bf16_f32 v145, v20, v21
    v_lshlrev_b32 v92, 16, v166
    v_mul_f32 v92, v92, v112
    v_cvt_pk_bf16_f32 v92, v92, v92
    v_lshlrev_b32 v92, 16, v92
    v_add_f32 v22, v22, v92
    v_cvt_pk_bf16_f32 v22, v22, v22
    v_lshlrev_b32 v22, 16, v22
    v_and_b32 v92, 0xffff0000, v166
    v_mul_f32 v92, v92, v113
    v_cvt_pk_bf16_f32 v92, v92, v92
    v_lshlrev_b32 v92, 16, v92
    v_add_f32 v23, v23, v92
    v_cvt_pk_bf16_f32 v23, v23, v23
    v_lshlrev_b32 v23, 16, v23
    v_cvt_pk_bf16_f32 v146, v22, v23
    v_lshlrev_b32 v92, 16, v167
    v_mul_f32 v92, v92, v114
    v_cvt_pk_bf16_f32 v92, v92, v92
    v_lshlrev_b32 v92, 16, v92
    v_add_f32 v24, v24, v92
    v_cvt_pk_bf16_f32 v24, v24, v24
    v_lshlrev_b32 v24, 16, v24
    v_and_b32 v92, 0xffff0000, v167
    v_mul_f32 v92, v92, v115
    v_cvt_pk_bf16_f32 v92, v92, v92
    v_lshlrev_b32 v92, 16, v92
    v_add_f32 v25, v25, v92
    v_cvt_pk_bf16_f32 v25, v25, v25
    v_lshlrev_b32 v25, 16, v25
    v_cvt_pk_bf16_f32 v147, v24, v25
    v_lshlrev_b32 v92, 16, v168
    v_mul_f32 v92, v92, v116
    v_cvt_pk_bf16_f32 v92, v92, v92
    v_lshlrev_b32 v92, 16, v92
    v_add_f32 v26, v26, v92
    v_cvt_pk_bf16_f32 v26, v26, v26
    v_lshlrev_b32 v26, 16, v26
    v_and_b32 v92, 0xffff0000, v168
    v_mul_f32 v92, v92, v117
    v_cvt_pk_bf16_f32 v92, v92, v92
    v_lshlrev_b32 v92, 16, v92
    v_add_f32 v27, v27, v92
    v_cvt_pk_bf16_f32 v27, v27, v27
    v_lshlrev_b32 v27, 16, v27
    v_cvt_pk_bf16_f32 v148, v26, v27
    v_lshlrev_b32 v92, 16, v169
    v_mul_f32 v92, v92, v118
    v_cvt_pk_bf16_f32 v92, v92, v92
    v_lshlrev_b32 v92, 16, v92
    v_add_f32 v28, v28, v92
    v_cvt_pk_bf16_f32 v28, v28, v28
    v_lshlrev_b32 v28, 16, v28
    v_and_b32 v92, 0xffff0000, v169
    v_mul_f32 v92, v92, v119
    v_cvt_pk_bf16_f32 v92, v92, v92
    v_lshlrev_b32 v92, 16, v92
    v_add_f32 v29, v29, v92
    v_cvt_pk_bf16_f32 v29, v29, v29
    v_lshlrev_b32 v29, 16, v29
    v_cvt_pk_bf16_f32 v149, v28, v29
    v_lshlrev_b32 v92, 16, v170
    v_mul_f32 v92, v92, v120
    v_cvt_pk_bf16_f32 v92, v92, v92
    v_lshlrev_b32 v92, 16, v92
    v_add_f32 v30, v30, v92
    v_cvt_pk_bf16_f32 v30, v30, v30
    v_lshlrev_b32 v30, 16, v30
    v_and_b32 v92, 0xffff0000, v170
    v_mul_f32 v92, v92, v121
    v_cvt_pk_bf16_f32 v92, v92, v92
    v_lshlrev_b32 v92, 16, v92
    v_add_f32 v31, v31, v92
    v_cvt_pk_bf16_f32 v31, v31, v31
    v_lshlrev_b32 v31, 16, v31
    v_cvt_pk_bf16_f32 v150, v30, v31
    v_lshlrev_b32 v92, 16, v171
    v_mul_f32 v92, v92, v122
    v_cvt_pk_bf16_f32 v92, v92, v92
    v_lshlrev_b32 v92, 16, v92
    v_add_f32 v32, v32, v92
    v_cvt_pk_bf16_f32 v32, v32, v32
    v_lshlrev_b32 v32, 16, v32
    v_and_b32 v92, 0xffff0000, v171
    v_mul_f32 v92, v92, v123
    v_cvt_pk_bf16_f32 v92, v92, v92
    v_lshlrev_b32 v92, 16, v92
    v_add_f32 v33, v33, v92
    v_cvt_pk_bf16_f32 v33, v33, v33
    v_lshlrev_b32 v33, 16, v33
    v_cvt_pk_bf16_f32 v151, v32, v33
    v_lshlrev_b32 v92, 16, v172
    v_mul_f32 v92, v92, v124
    v_cvt_pk_bf16_f32 v92, v92, v92
    v_lshlrev_b32 v92, 16, v92
    v_add_f32 v34, v34, v92
    v_cvt_pk_bf16_f32 v34, v34, v34
    v_lshlrev_b32 v34, 16, v34
    v_and_b32 v92, 0xffff0000, v172
    v_mul_f32 v92, v92, v125
    v_cvt_pk_bf16_f32 v92, v92, v92
    v_lshlrev_b32 v92, 16, v92
    v_add_f32 v35, v35, v92
    v_cvt_pk_bf16_f32 v35, v35, v35
    v_lshlrev_b32 v35, 16, v35
    v_cvt_pk_bf16_f32 v152, v34, v35
    v_lshlrev_b32 v92, 16, v173
    v_mul_f32 v92, v92, v126
    v_cvt_pk_bf16_f32 v92, v92, v92
    v_lshlrev_b32 v92, 16, v92
    v_add_f32 v36, v36, v92
    v_cvt_pk_bf16_f32 v36, v36, v36
    v_lshlrev_b32 v36, 16, v36
    v_and_b32 v92, 0xffff0000, v173
    v_mul_f32 v92, v92, v127
    v_cvt_pk_bf16_f32 v92, v92, v92
    v_lshlrev_b32 v92, 16, v92
    v_add_f32 v37, v37, v92
    v_cvt_pk_bf16_f32 v37, v37, v37
    v_lshlrev_b32 v37, 16, v37
    v_cvt_pk_bf16_f32 v153, v36, v37
    v_lshlrev_b32 v92, 16, v174
    v_mul_f32 v92, v92, v128
    v_cvt_pk_bf16_f32 v92, v92, v92
    v_lshlrev_b32 v92, 16, v92
    v_add_f32 v38, v38, v92
    v_cvt_pk_bf16_f32 v38, v38, v38
    v_lshlrev_b32 v38, 16, v38
    v_and_b32 v92, 0xffff0000, v174
    v_mul_f32 v92, v92, v129
    v_cvt_pk_bf16_f32 v92, v92, v92
    v_lshlrev_b32 v92, 16, v92
    v_add_f32 v39, v39, v92
    v_cvt_pk_bf16_f32 v39, v39, v39
    v_lshlrev_b32 v39, 16, v39
    v_cvt_pk_bf16_f32 v154, v38, v39
    v_lshlrev_b32 v92, 16, v175
    v_mul_f32 v92, v92, v130
    v_cvt_pk_bf16_f32 v92, v92, v92
    v_lshlrev_b32 v92, 16, v92
    v_add_f32 v40, v40, v92
    v_cvt_pk_bf16_f32 v40, v40, v40
    v_lshlrev_b32 v40, 16, v40
    v_and_b32 v92, 0xffff0000, v175
    v_mul_f32 v92, v92, v131
    v_cvt_pk_bf16_f32 v92, v92, v92
    v_lshlrev_b32 v92, 16, v92
    v_add_f32 v41, v41, v92
    v_cvt_pk_bf16_f32 v41, v41, v41
    v_lshlrev_b32 v41, 16, v41
    v_cvt_pk_bf16_f32 v155, v40, v41
    v_lshlrev_b32 v92, 16, v176
    v_mul_f32 v92, v92, v132
    v_cvt_pk_bf16_f32 v92, v92, v92
    v_lshlrev_b32 v92, 16, v92
    v_add_f32 v42, v42, v92
    v_cvt_pk_bf16_f32 v42, v42, v42
    v_lshlrev_b32 v42, 16, v42
    v_and_b32 v92, 0xffff0000, v176
    v_mul_f32 v92, v92, v133
    v_cvt_pk_bf16_f32 v92, v92, v92
    v_lshlrev_b32 v92, 16, v92
    v_add_f32 v43, v43, v92
    v_cvt_pk_bf16_f32 v43, v43, v43
    v_lshlrev_b32 v43, 16, v43
    v_cvt_pk_bf16_f32 v156, v42, v43
    v_lshlrev_b32 v92, 16, v177
    v_mul_f32 v92, v92, v134
    v_cvt_pk_bf16_f32 v92, v92, v92
    v_lshlrev_b32 v92, 16, v92
    v_add_f32 v44, v44, v92
    v_cvt_pk_bf16_f32 v44, v44, v44
    v_lshlrev_b32 v44, 16, v44
    v_and_b32 v92, 0xffff0000, v177
    v_mul_f32 v92, v92, v135
    v_cvt_pk_bf16_f32 v92, v92, v92
    v_lshlrev_b32 v92, 16, v92
    v_add_f32 v45, v45, v92
    v_cvt_pk_bf16_f32 v45, v45, v45
    v_lshlrev_b32 v45, 16, v45
    v_cvt_pk_bf16_f32 v157, v44, v45
    v_lshlrev_b32 v92, 16, v178
    v_mul_f32 v92, v92, v136
    v_cvt_pk_bf16_f32 v92, v92, v92
    v_lshlrev_b32 v92, 16, v92
    v_add_f32 v46, v46, v92
    v_cvt_pk_bf16_f32 v46, v46, v46
    v_lshlrev_b32 v46, 16, v46
    v_and_b32 v92, 0xffff0000, v178
    v_mul_f32 v92, v92, v137
    v_cvt_pk_bf16_f32 v92, v92, v92
    v_lshlrev_b32 v92, 16, v92
    v_add_f32 v47, v47, v92
    v_cvt_pk_bf16_f32 v47, v47, v47
    v_lshlrev_b32 v47, 16, v47
    v_cvt_pk_bf16_f32 v158, v46, v47
    v_lshlrev_b32 v92, 16, v179
    v_mul_f32 v92, v92, v138
    v_cvt_pk_bf16_f32 v92, v92, v92
    v_lshlrev_b32 v92, 16, v92
    v_add_f32 v48, v48, v92
    v_cvt_pk_bf16_f32 v48, v48, v48
    v_lshlrev_b32 v48, 16, v48
    v_and_b32 v92, 0xffff0000, v179
    v_mul_f32 v92, v92, v139
    v_cvt_pk_bf16_f32 v92, v92, v92
    v_lshlrev_b32 v92, 16, v92
    v_add_f32 v49, v49, v92
    v_cvt_pk_bf16_f32 v49, v49, v49
    v_lshlrev_b32 v49, 16, v49
    v_cvt_pk_bf16_f32 v159, v48, v49
    buffer_store_dwordx4 v[140:143], v3, s[16:19], 0 offen offset:0
    buffer_store_dwordx4 v[144:147], v3, s[16:19], 0 offen offset:256
    buffer_store_dwordx4 v[148:151], v3, s[16:19], 0 offen offset:512
    buffer_store_dwordx4 v[152:155], v3, s[16:19], 0 offen offset:768
    buffer_store_dwordx4 v[156:159], v3, s[16:19], 0 offen offset:1024
    v_mov_b32 v90, v10
    v_add_f32 v90, v90, v11
    v_add_f32 v90, v90, v12
    v_add_f32 v90, v90, v13
    v_add_f32 v90, v90, v14
    v_add_f32 v90, v90, v15
    v_add_f32 v90, v90, v16
    v_add_f32 v90, v90, v17
    v_add_f32 v90, v90, v18
    v_add_f32 v90, v90, v19
    v_add_f32 v90, v90, v20
    v_add_f32 v90, v90, v21
    v_add_f32 v90, v90, v22
    v_add_f32 v90, v90, v23
    v_add_f32 v90, v90, v24
    v_add_f32 v90, v90, v25
    v_add_f32 v90, v90, v26
    v_add_f32 v90, v90, v27
    v_add_f32 v90, v90, v28
    v_add_f32 v90, v90, v29
    v_add_f32 v90, v90, v30
    v_add_f32 v90, v90, v31
    v_add_f32 v90, v90, v32
    v_add_f32 v90, v90, v33
    v_add_f32 v90, v90, v34
    v_add_f32 v90, v90, v35
    v_add_f32 v90, v90, v36
    v_add_f32 v90, v90, v37
    v_add_f32 v90, v90, v38
    v_add_f32 v90, v90, v39
    v_add_f32 v90, v90, v40
    v_add_f32 v90, v90, v41
    v_add_f32 v90, v90, v42
    v_add_f32 v90, v90, v43
    v_add_f32 v90, v90, v44
    v_add_f32 v90, v90, v45
    v_add_f32 v90, v90, v46
    v_add_f32 v90, v90, v47
    v_add_f32 v90, v90, v48
    v_add_f32 v90, v90, v49
    s_nop 1
    v_add_f32_dpp v90, v90, v90 row_ror:8 row_mask:0xf bank_mask:0xf
    s_nop 1
    v_add_f32_dpp v90, v90, v90 row_ror:4 row_mask:0xf bank_mask:0xf
    s_nop 1
    v_add_f32_dpp v90, v90, v90 row_ror:2 row_mask:0xf bank_mask:0xf
    s_nop 1
    v_add_f32_dpp v90, v90, v90 row_ror:1 row_mask:0xf bank_mask:0xf
    v_mul_f32 v90, 0.0015625, v90
    v_mov_b32 v91, 0
    v_sub_f32 v92, v10, v90
    v_fmac_f32 v91, v92, v92
    v_sub_f32 v92, v11, v90
    v_fmac_f32 v91, v92, v92
    v_sub_f32 v92, v12, v90
    v_fmac_f32 v91, v92, v92
    v_sub_f32 v92, v13, v90
    v_fmac_f32 v91, v92, v92
    v_sub_f32 v92, v14, v90
    v_fmac_f32 v91, v92, v92
    v_sub_f32 v92, v15, v90
    v_fmac_f32 v91, v92, v92
    v_sub_f32 v92, v16, v90
    v_fmac_f32 v91, v92, v92
    v_sub_f32 v92, v17, v90
    v_fmac_f32 v91, v92, v92
    v_sub_f32 v92, v18, v90
    v_fmac_f32 v91, v92, v92
    v_sub_f32 v92, v19, v90
    v_fmac_f32 v91, v92, v92
    v_sub_f32 v92, v20, v90
    v_fmac_f32 v91, v92, v92
    v_sub_f32 v92, v21, v90
    v_fmac_f32 v91, v92, v92
    v_sub_f32 v92, v22, v90
    v_fmac_f32 v91, v92, v92
    v_sub_f32 v92, v23, v90
    v_fmac_f32 v91, v92, v92
    v_sub_f32 v92, v24, v90
    v_fmac_f32 v91, v92, v92
    v_sub_f32 v92, v25, v90
    v_fmac_f32 v91, v92, v92
    v_sub_f32 v92, v26, v90
    v_fmac_f32 v91, v92, v92
    v_sub_f32 v92, v27, v90
    v_fmac_f32 v91, v92, v92
    v_sub_f32 v92, v28, v90
    v_fmac_f32 v91, v92, v92
    v_sub_f32 v92, v29, v90
    v_fmac_f32 v91, v92, v92
    v_sub_f32 v92, v30, v90
    v_fmac_f32 v91, v92, v92
    v_sub_f32 v92, v31, v90
    v_fmac_f32 v91, v92, v92
    v_sub_f32 v92, v32, v90
    v_fmac_f32 v91, v92, v92
    v_sub_f32 v92, v33, v90
    v_fmac_f32 v91, v92, v92
    v_sub_f32 v92, v34, v90
    v_fmac_f32 v91, v92, v92
    v_sub_f32 v92, v35, v90
    v_fmac_f32 v91, v92, v92
    v_sub_f32 v92, v36, v90
    v_fmac_f32 v91, v92, v92
    v_sub_f32 v92, v37, v90
    v_fmac_f32 v91, v92, v92
    v_sub_f32 v92, v38, v90
    v_fmac_f32 v91, v92, v92
    v_sub_f32 v92, v39, v90
    v_fmac_f32 v91, v92, v92
    v_sub_f32 v92, v40, v90
    v_fmac_f32 v91, v92, v92
    v_sub_f32 v92, v41, v90
    v_fmac_f32 v91, v92, v92
    v_sub_f32 v92, v42, v90
    v_fmac_f32 v91, v92, v92
    v_sub_f32 v92, v43, v90
    v_fmac_f32 v91, v92, v92
    v_sub_f32 v92, v44, v90
    v_fmac_f32 v91, v92, v92
    v_sub_f32 v92, v45, v90
    v_fmac_f32 v91, v92, v92
    v_sub_f32 v92, v46, v90
    v_fmac_f32 v91, v92, v92
    v_sub_f32 v92, v47, v90
    v_fmac_f32 v91, v92, v92
    v_sub_f32 v92, v48, v90
    v_fmac_f32 v91, v92, v92
    v_sub_f32 v92, v49, v90
    v_fmac_f32 v91, v92, v92
    s_nop 1
    v_add_f32_dpp v91, v91, v91 row_ror:8 row_mask:0xf bank_mask:0xf
    s_nop 1
    v_add_f32_dpp v91, v91, v91 row_ror:4 row_mask:0xf bank_mask:0xf
    s_nop 1
    v_add_f32_dpp v91, v91, v91 row_ror:2 row_mask:0xf bank_mask:0xf
    s_nop 1
    v_add_f32_dpp v91, v91, v91 row_ror:1 row_mask:0xf bank_mask:0xf
    v_mul_f32 v91, 0.0015625, v91
    v_cvt_pk_bf16_f32 v91, v91, v91
    v_lshlrev_b32 v91, 16, v91
    v_add_f32 v91, 0x3727c5ac, v91
    v_cvt_pk_bf16_f32 v91, v91, v91
    v_lshlrev_b32 v91, 16, v91
    v_sqrt_f32 v91, v91
    s_nop 0
    v_cvt_pk_bf16_f32 v91, v91, v91
    v_lshlrev_b32 v91, 16, v91
    v_rcp_f32 v91, v91
    v_cvt_pk_bf16_f32 v90, v90, v90
    v_lshlrev_b32 v90, 16, v90
    v_sub_f32 v100, v10, v90
    v_cvt_pk_bf16_f32 v100, v100, v100
    v_lshlrev_b32 v100, 16, v100
    v_mul_f32 v100, v100, v91
    v_cvt_pk_bf16_f32 v100, v100, v100
    v_lshlrev_b32 v100, 16, v100
    v_sub_f32 v101, v11, v90
    v_cvt_pk_bf16_f32 v101, v101, v101
    v_lshlrev_b32 v101, 16, v101
    v_mul_f32 v101, v101, v91
    v_cvt_pk_bf16_f32 v101, v101, v101
    v_lshlrev_b32 v101, 16, v101
    v_sub_f32 v102, v12, v90
    v_cvt_pk_bf16_f32 v102, v102, v102
    v_lshlrev_b32 v102, 16, v102
    v_mul_f32 v102, v102, v91
    v_cvt_pk_bf16_f32 v102, v102, v102
    v_lshlrev_b32 v102, 16, v102
    v_sub_f32 v103, v13, v90
    v_cvt_pk_bf16_f32 v103, v103, v103
    v_lshlrev_b32 v103, 16, v103
    v_mul_f32 v103, v103, v91
    v_cvt_pk_bf16_f32 v103, v103, v103
    v_lshlrev_b32 v103, 16, v103
    v_sub_f32 v104, v14, v90
    v_cvt_pk_bf16_f32 v104, v104, v104
    v_lshlrev_b32 v104, 16, v104
    v_mul_f32 v104, v104, v91
    v_cvt_pk_bf16_f32 v104, v104, v104
    v_lshlrev_b32 v104, 16, v104
    v_sub_f32 v105, v15, v90
    v_cvt_pk_bf16_f32 v105, v105, v105
    v_lshlrev_b32 v105, 16, v105
    v_mul_f32 v105, v105, v91
    v_cvt_pk_bf16_f32 v105, v105, v105
    v_lshlrev_b32 v105, 16, v105
    v_sub_f32 v106, v16, v90
    v_cvt_pk_bf16_f32 v106, v106, v106
    v_lshlrev_b32 v106, 16, v106
    v_mul_f32 v106, v106, v91
    v_cvt_pk_bf16_f32 v106, v106, v106
    v_lshlrev_b32 v106, 16, v106
    v_sub_f32 v107, v17, v90
    v_cvt_pk_bf16_f32 v107, v107, v107
    v_lshlrev_b32 v107, 16, v107
    v_mul_f32 v107, v107, v91
    v_cvt_pk_bf16_f32 v107, v107, v107
    v_lshlrev_b32 v107, 16, v107
    v_sub_f32 v108, v18, v90
    v_cvt_pk_bf16_f32 v108, v108, v108
    v_lshlrev_b32 v108, 16, v108
    v_mul_f32 v108, v108, v91
    v_cvt_pk_bf16_f32 v108, v108, v108
    v_lshlrev_b32 v108, 16, v108
    v_sub_f32 v109, v19, v90
    v_cvt_pk_bf16_f32 v109, v109, v109
    v_lshlrev_b32 v109, 16, v109
    v_mul_f32 v109, v109, v91
    v_cvt_pk_bf16_f32 v109, v109, v109
    v_lshlrev_b32 v109, 16, v109
    v_sub_f32 v110, v20, v90
    v_cvt_pk_bf16_f32 v110, v110, v110
    v_lshlrev_b32 v110, 16, v110
    v_mul_f32 v110, v110, v91
    v_cvt_pk_bf16_f32 v110, v110, v110
    v_lshlrev_b32 v110, 16, v110
    v_sub_f32 v111, v21, v90
    v_cvt_pk_bf16_f32 v111, v111, v111
    v_lshlrev_b32 v111, 16, v111
    v_mul_f32 v111, v111, v91
    v_cvt_pk_bf16_f32 v111, v111, v111
    v_lshlrev_b32 v111, 16, v111
    v_sub_f32 v112, v22, v90
    v_cvt_pk_bf16_f32 v112, v112, v112
    v_lshlrev_b32 v112, 16, v112
    v_mul_f32 v112, v112, v91
    v_cvt_pk_bf16_f32 v112, v112, v112
    v_lshlrev_b32 v112, 16, v112
    v_sub_f32 v113, v23, v90
    v_cvt_pk_bf16_f32 v113, v113, v113
    v_lshlrev_b32 v113, 16, v113
    v_mul_f32 v113, v113, v91
    v_cvt_pk_bf16_f32 v113, v113, v113
    v_lshlrev_b32 v113, 16, v113
    v_sub_f32 v114, v24, v90
    v_cvt_pk_bf16_f32 v114, v114, v114
    v_lshlrev_b32 v114, 16, v114
    v_mul_f32 v114, v114, v91
    v_cvt_pk_bf16_f32 v114, v114, v114
    v_lshlrev_b32 v114, 16, v114
    v_sub_f32 v115, v25, v90
    v_cvt_pk_bf16_f32 v115, v115, v115
    v_lshlrev_b32 v115, 16, v115
    v_mul_f32 v115, v115, v91
    v_cvt_pk_bf16_f32 v115, v115, v115
    v_lshlrev_b32 v115, 16, v115
    v_sub_f32 v116, v26, v90
    v_cvt_pk_bf16_f32 v116, v116, v116
    v_lshlrev_b32 v116, 16, v116
    v_mul_f32 v116, v116, v91
    v_cvt_pk_bf16_f32 v116, v116, v116
    v_lshlrev_b32 v116, 16, v116
    v_sub_f32 v117, v27, v90
    v_cvt_pk_bf16_f32 v117, v117, v117
    v_lshlrev_b32 v117, 16, v117
    v_mul_f32 v117, v117, v91
    v_cvt_pk_bf16_f32 v117, v117, v117
    v_lshlrev_b32 v117, 16, v117
    v_sub_f32 v118, v28, v90
    v_cvt_pk_bf16_f32 v118, v118, v118
    v_lshlrev_b32 v118, 16, v118
    v_mul_f32 v118, v118, v91
    v_cvt_pk_bf16_f32 v118, v118, v118
    v_lshlrev_b32 v118, 16, v118
    v_sub_f32 v119, v29, v90
    v_cvt_pk_bf16_f32 v119, v119, v119
    v_lshlrev_b32 v119, 16, v119
    v_mul_f32 v119, v119, v91
    v_cvt_pk_bf16_f32 v119, v119, v119
    v_lshlrev_b32 v119, 16, v119
    v_sub_f32 v120, v30, v90
    v_cvt_pk_bf16_f32 v120, v120, v120
    v_lshlrev_b32 v120, 16, v120
    v_mul_f32 v120, v120, v91
    v_cvt_pk_bf16_f32 v120, v120, v120
    v_lshlrev_b32 v120, 16, v120
    v_sub_f32 v121, v31, v90
    v_cvt_pk_bf16_f32 v121, v121, v121
    v_lshlrev_b32 v121, 16, v121
    v_mul_f32 v121, v121, v91
    v_cvt_pk_bf16_f32 v121, v121, v121
    v_lshlrev_b32 v121, 16, v121
    v_sub_f32 v122, v32, v90
    v_cvt_pk_bf16_f32 v122, v122, v122
    v_lshlrev_b32 v122, 16, v122
    v_mul_f32 v122, v122, v91
    v_cvt_pk_bf16_f32 v122, v122, v122
    v_lshlrev_b32 v122, 16, v122
    v_sub_f32 v123, v33, v90
    v_cvt_pk_bf16_f32 v123, v123, v123
    v_lshlrev_b32 v123, 16, v123
    v_mul_f32 v123, v123, v91
    v_cvt_pk_bf16_f32 v123, v123, v123
    v_lshlrev_b32 v123, 16, v123
    v_sub_f32 v124, v34, v90
    v_cvt_pk_bf16_f32 v124, v124, v124
    v_lshlrev_b32 v124, 16, v124
    v_mul_f32 v124, v124, v91
    v_cvt_pk_bf16_f32 v124, v124, v124
    v_lshlrev_b32 v124, 16, v124
    v_sub_f32 v125, v35, v90
    v_cvt_pk_bf16_f32 v125, v125, v125
    v_lshlrev_b32 v125, 16, v125
    v_mul_f32 v125, v125, v91
    v_cvt_pk_bf16_f32 v125, v125, v125
    v_lshlrev_b32 v125, 16, v125
    v_sub_f32 v126, v36, v90
    v_cvt_pk_bf16_f32 v126, v126, v126
    v_lshlrev_b32 v126, 16, v126
    v_mul_f32 v126, v126, v91
    v_cvt_pk_bf16_f32 v126, v126, v126
    v_lshlrev_b32 v126, 16, v126
    v_sub_f32 v127, v37, v90
    v_cvt_pk_bf16_f32 v127, v127, v127
    v_lshlrev_b32 v127, 16, v127
    v_mul_f32 v127, v127, v91
    v_cvt_pk_bf16_f32 v127, v127, v127
    v_lshlrev_b32 v127, 16, v127
    v_sub_f32 v128, v38, v90
    v_cvt_pk_bf16_f32 v128, v128, v128
    v_lshlrev_b32 v128, 16, v128
    v_mul_f32 v128, v128, v91
    v_cvt_pk_bf16_f32 v128, v128, v128
    v_lshlrev_b32 v128, 16, v128
    v_sub_f32 v129, v39, v90
    v_cvt_pk_bf16_f32 v129, v129, v129
    v_lshlrev_b32 v129, 16, v129
    v_mul_f32 v129, v129, v91
    v_cvt_pk_bf16_f32 v129, v129, v129
    v_lshlrev_b32 v129, 16, v129
    v_sub_f32 v130, v40, v90
    v_cvt_pk_bf16_f32 v130, v130, v130
    v_lshlrev_b32 v130, 16, v130
    v_mul_f32 v130, v130, v91
    v_cvt_pk_bf16_f32 v130, v130, v130
    v_lshlrev_b32 v130, 16, v130
    v_sub_f32 v131, v41, v90
    v_cvt_pk_bf16_f32 v131, v131, v131
    v_lshlrev_b32 v131, 16, v131
    v_mul_f32 v131, v131, v91
    v_cvt_pk_bf16_f32 v131, v131, v131
    v_lshlrev_b32 v131, 16, v131
    v_sub_f32 v132, v42, v90
    v_cvt_pk_bf16_f32 v132, v132, v132
    v_lshlrev_b32 v132, 16, v132
    v_mul_f32 v132, v132, v91
    v_cvt_pk_bf16_f32 v132, v132, v132
    v_lshlrev_b32 v132, 16, v132
    v_sub_f32 v133, v43, v90
    v_cvt_pk_bf16_f32 v133, v133, v133
    v_lshlrev_b32 v133, 16, v133
    v_mul_f32 v133, v133, v91
    v_cvt_pk_bf16_f32 v133, v133, v133
    v_lshlrev_b32 v133, 16, v133
    v_sub_f32 v134, v44, v90
    v_cvt_pk_bf16_f32 v134, v134, v134
    v_lshlrev_b32 v134, 16, v134
    v_mul_f32 v134, v134, v91
    v_cvt_pk_bf16_f32 v134, v134, v134
    v_lshlrev_b32 v134, 16, v134
    v_sub_f32 v135, v45, v90
    v_cvt_pk_bf16_f32 v135, v135, v135
    v_lshlrev_b32 v135, 16, v135
    v_mul_f32 v135, v135, v91
    v_cvt_pk_bf16_f32 v135, v135, v135
    v_lshlrev_b32 v135, 16, v135
    v_sub_f32 v136, v46, v90
    v_cvt_pk_bf16_f32 v136, v136, v136
    v_lshlrev_b32 v136, 16, v136
    v_mul_f32 v136, v136, v91
    v_cvt_pk_bf16_f32 v136, v136, v136
    v_lshlrev_b32 v136, 16, v136
    v_sub_f32 v137, v47, v90
    v_cvt_pk_bf16_f32 v137, v137, v137
    v_lshlrev_b32 v137, 16, v137
    v_mul_f32 v137, v137, v91
    v_cvt_pk_bf16_f32 v137, v137, v137
    v_lshlrev_b32 v137, 16, v137
    v_sub_f32 v138, v48, v90
    v_cvt_pk_bf16_f32 v138, v138, v138
    v_lshlrev_b32 v138, 16, v138
    v_mul_f32 v138, v138, v91
    v_cvt_pk_bf16_f32 v138, v138, v138
    v_lshlrev_b32 v138, 16, v138
    v_sub_f32 v139, v49, v90
    v_cvt_pk_bf16_f32 v139, v139, v139
    v_lshlrev_b32 v139, 16, v139
    v_mul_f32 v139, v139, v91
    v_cvt_pk_bf16_f32 v139, v139, v139
    v_lshlrev_b32 v139, 16, v139
    v_cvt_pk_bf16_f32 v160, v100, v101
    v_cvt_pk_bf16_f32 v161, v102, v103
    v_cvt_pk_bf16_f32 v162, v104, v105
    v_cvt_pk_bf16_f32 v163, v106, v107
    v_cvt_pk_bf16_f32 v164, v108, v109
    v_cvt_pk_bf16_f32 v165, v110, v111
    v_cvt_pk_bf16_f32 v166, v112, v113
    v_cvt_pk_bf16_f32 v167, v114, v115
    v_cvt_pk_bf16_f32 v168, v116, v117
    v_cvt_pk_bf16_f32 v169, v118, v119
    v_cvt_pk_bf16_f32 v170, v120, v121
    v_cvt_pk_bf16_f32 v171, v122, v123
    v_cvt_pk_bf16_f32 v172, v124, v125
    v_cvt_pk_bf16_f32 v173, v126, v127
    v_cvt_pk_bf16_f32 v174, v128, v129
    v_cvt_pk_bf16_f32 v175, v130, v131
    v_cvt_pk_bf16_f32 v176, v132, v133
    v_cvt_pk_bf16_f32 v177, v134, v135
    v_cvt_pk_bf16_f32 v178, v136, v137
    v_cvt_pk_bf16_f32 v179, v138, v139
    v_lshrrev_b32 v4, 5, v1
    v_mul_u32_u24 v4, 42240, v4
    v_and_b32 v5, 31, v1
    v_lshl_add_u32 v4, v5, 4, v4
    v_lshl_add_u32 v4, v2, 9, v4
    buffer_store_dwordx4 v[160:163], v4, s[20:23], 0 offen
    v_add_u32 v4, 8192, v4
    buffer_store_dwordx4 v[164:167], v4, s[20:23], 0 offen
    v_add_u32 v4, 8192, v4
    buffer_store_dwordx4 v[168:171], v4, s[20:23], 0 offen
    v_add_u32 v4, 8192, v4
    buffer_store_dwordx4 v[172:175], v4, s[20:23], 0 offen
    v_add_u32 v4, 8192, v4
    buffer_store_dwordx4 v[176:179], v4, s[20:23], 0 offen
    v_add_u32 v4, 8192, v4
k4_kernel_end:
    s_endpgm
.globl k5_kernel
.p2align 8
.type k5_kernel,@function
k5_kernel:
    s_cmp_ge_u32 s2, 216
    s_cbranch_scc1 k5_kernel_end
    s_load_dwordx2 s[4:5], s[0:1], 96
    s_load_dwordx2 s[6:7], s[0:1], 80
    s_lshr_b32 s3, s2, 3
    s_mul_hi_u32 s24, s3, 159072863
    s_mul_i32 s25, s24, 27
    s_sub_u32 s25, s3, s25
    s_and_b32 s3, s2, 7
    s_lshl_b32 s3, s3, 2
    s_add_u32 s24, s24, s3
    v_and_b32 v9, 63, v0
    v_lshlrev_b32 v9, 4, v9
    v_lshrrev_b32 v8, 6, v0
    s_nop 1
    v_readfirstlane_b32 s26, v8
    s_and_b32 s3, s2, 7
    s_mul_i32 s3, s3, 27
    s_lshr_b32 s24, s2, 3
    s_add_u32 s3, s3, s24
    s_lshr_b32 s25, s3, 3
    s_and_b32 s24, s3, 7
    s_lshl_b32 s24, s24, 2
    s_add_u32 s24, s24, s26
    s_waitcnt lgkmcnt(0)
    s_add_u32 s8, s4, 19922944
    s_addc_u32 s9, s5, 0
    s_and_b32 s9, s9, 0xffff
    s_mov_b32 s10, 2703360
    s_mov_b32 s11, 0x00020000
    s_add_u32 s12, s4, 0
    s_addc_u32 s13, s5, 0
    s_and_b32 s13, s13, 0xffff
    s_mov_b32 s14, 4561920
    s_mov_b32 s15, 0x00020000
    s_add_u32 s16, s4, 23068672
    s_addc_u32 s17, s5, 0
    s_and_b32 s17, s17, 0xffff
    s_mov_b32 s18, 7159808
    s_mov_b32 s19, 0x00020000
    s_lshl_b32 s27, s24, 1
    s_add_u32 s27, s27, 0
    s_mul_i32 s27, s27, 42240
    v_add_u32 v1, s27, v9
    s_lshl_b32 s27, s24, 1
    s_add_u32 s27, s27, 1
    s_mul_i32 s27, s27, 42240
    v_add_u32 v2, s27, v9
    s_mul_i32 s27, s25, 4
    s_add_u32 s27, s27, 0
    s_mul_i32 s27, s27, 42240
    v_add_u32 v3, s27, v9
    s_mul_i32 s27, s25, 4
    s_add_u32 s27, s27, 1
    s_mul_i32 s27, s27, 42240
    v_add_u32 v4, s27, v9
    s_mul_i32 s27, s25, 4
    s_add_u32 s27, s27, 2
    s_mul_i32 s27, s27, 42240
    v_add_u32 v5, s27, v9
    s_mul_i32 s27, s25, 4
    s_add_u32 s27, s27, 3
    s_mul_i32 s27, s27, 42240
    v_add_u32 v6, s27, v9
    v_mov_b32 v80, 0
    v_mov_b32 v81, 0
    v_mov_b32 v82, 0
    v_mov_b32 v83, 0
    v_mov_b32 v84, 0
    v_mov_b32 v85, 0
    v_mov_b32 v86, 0
    v_mov_b32 v87, 0
    v_mov_b32 v88, 0
    v_mov_b32 v89, 0
    v_mov_b32 v90, 0
    v_mov_b32 v91, 0
    v_mov_b32 v92, 0
    v_mov_b32 v93, 0
    v_mov_b32 v94, 0
    v_mov_b32 v95, 0
    v_mov_b32 v96, 0
    v_mov_b32 v97, 0
    v_mov_b32 v98, 0
    v_mov_b32 v99, 0
    v_mov_b32 v100, 0
    v_mov_b32 v101, 0
    v_mov_b32 v102, 0
    v_mov_b32 v103, 0
    v_mov_b32 v104, 0
    v_mov_b32 v105, 0
    v_mov_b32 v106, 0
    v_mov_b32 v107, 0
    v_mov_b32 v108, 0
    v_mov_b32 v109, 0
    v_mov_b32 v110, 0
    v_mov_b32 v111, 0
    v_mov_b32 v112, 0
    v_mov_b32 v113, 0
    v_mov_b32 v114, 0
    v_mov_b32 v115, 0
    v_mov_b32 v116, 0
    v_mov_b32 v117, 0
    v_mov_b32 v118, 0
    v_mov_b32 v119, 0
    v_mov_b32 v120, 0
    v_mov_b32 v121, 0
    v_mov_b32 v122, 0
    v_mov_b32 v123, 0
    v_mov_b32 v124, 0
    v_mov_b32 v125, 0
    v_mov_b32 v126, 0
    v_mov_b32 v127, 0
    v_mov_b32 v128, 0
    v_mov_b32 v129, 0
    v_mov_b32 v130, 0
    v_mov_b32 v131, 0
    v_mov_b32 v132, 0
    v_mov_b32 v133, 0
    v_mov_b32 v134, 0
    v_mov_b32 v135, 0
    v_mov_b32 v136, 0
    v_mov_b32 v137, 0
    v_mov_b32 v138, 0
    v_mov_b32 v139, 0
    v_mov_b32 v140, 0
    v_mov_b32 v141, 0
    v_mov_b32 v142, 0
    v_mov_b32 v143, 0
    v_mov_b32 v144, 0
    v_mov_b32 v145, 0
    v_mov_b32 v146, 0
    v_mov_b32 v147, 0
    v_mov_b32 v148, 0
    v_mov_b32 v149, 0
    v_mov_b32 v150, 0
    v_mov_b32 v151, 0
    v_mov_b32 v152, 0
    v_mov_b32 v153, 0
    v_mov_b32 v154, 0
    v_mov_b32 v155, 0
    v_mov_b32 v156, 0
    v_mov_b32 v157, 0
    v_mov_b32 v158, 0
    v_mov_b32 v159, 0
    v_mov_b32 v160, 0
    v_mov_b32 v161, 0
    v_mov_b32 v162, 0
    v_mov_b32 v163, 0
    v_mov_b32 v164, 0
    v_mov_b32 v165, 0
    v_mov_b32 v166, 0
    v_mov_b32 v167, 0
    v_mov_b32 v168, 0
    v_mov_b32 v169, 0
    v_mov_b32 v170, 0
    v_mov_b32 v171, 0
    v_mov_b32 v172, 0
    v_mov_b32 v173, 0
    v_mov_b32 v174, 0
    v_mov_b32 v175, 0
    v_mov_b32 v176, 0
    v_mov_b32 v177, 0
    v_mov_b32 v178, 0
    v_mov_b32 v179, 0
    v_mov_b32 v180, 0
    v_mov_b32 v181, 0
    v_mov_b32 v182, 0
    v_mov_b32 v183, 0
    v_mov_b32 v184, 0
    v_mov_b32 v185, 0
    v_mov_b32 v186, 0
    v_mov_b32 v187, 0
    v_mov_b32 v188, 0
    v_mov_b32 v189, 0
    v_mov_b32 v190, 0
    v_mov_b32 v191, 0
    v_mov_b32 v192, 0
    v_mov_b32 v193, 0
    v_mov_b32 v194, 0
    v_mov_b32 v195, 0
    v_mov_b32 v196, 0
    v_mov_b32 v197, 0
    v_mov_b32 v198, 0
    v_mov_b32 v199, 0
    v_mov_b32 v200, 0
    v_mov_b32 v201, 0
    v_mov_b32 v202, 0
    v_mov_b32 v203, 0
    v_mov_b32 v204, 0
    v_mov_b32 v205, 0
    v_mov_b32 v206, 0
    v_mov_b32 v207, 0
    s_mul_i32 s27, s25, 4
    s_add_u32 s27, s27, s26
    s_mul_i32 s27, s27, 42240
    v_add_u32 v3, s27, v9
    s_lshl_b32 s27, s26, 12
    v_add_u32 v4, s27, v9
    s_mov_b32 s33, 0
    s_mov_b32 s34, 0
    buffer_load_dwordx4 v[48:51], v3, s[12:15], s34 offen offset:0
    buffer_load_dwordx4 v[52:55], v3, s[12:15], s34 offen offset:1024
    buffer_load_dwordx4 v[56:59], v3, s[12:15], s34 offen offset:2048
    buffer_load_dwordx4 v[60:63], v3, s[12:15], s34 offen offset:3072
    s_add_u32 s34, s34, 4096
    s_waitcnt vmcnt(0)
    ds_write_b128 v4, v[48:51] offset:0
    ds_write_b128 v4, v[52:55] offset:1024
    ds_write_b128 v4, v[56:59] offset:2048
    ds_write_b128 v4, v[60:63] offset:3072
    buffer_load_dwordx4 v[48:51], v3, s[12:15], s34 offen offset:0
    buffer_load_dwordx4 v[52:55], v3, s[12:15], s34 offen offset:1024
    buffer_load_dwordx4 v[56:59], v3, s[12:15], s34 offen offset:2048
    buffer_load_dwordx4 v[60:63], v3, s[12:15], s34 offen offset:3072
    s_add_u32 s34, s34, 4096
    buffer_load_dwordx4 v[16:19], v1, s[8:11], s33 offen
    buffer_load_dwordx4 v[20:23], v2, s[8:11], s33 offen
    s_add_u32 s33, s33, 1024
    buffer_load_dwordx4 v[24:27], v1, s[8:11], s33 offen
    buffer_load_dwordx4 v[28:31], v2, s[8:11], s33 offen
    s_add_u32 s33, s33, 1024
    buffer_load_dwordx4 v[32:35], v1, s[8:11], s33 offen
    buffer_load_dwordx4 v[36:39], v2, s[8:11], s33 offen
    s_add_u32 s33, s33, 1024
    buffer_load_dwordx4 v[40:43], v1, s[8:11], s33 offen
    buffer_load_dwordx4 v[44:47], v2, s[8:11], s33 offen
    s_add_u32 s33, s33, 1024
    s_waitcnt lgkmcnt(0)
    s_barrier
    s_mov_b32 s36, 0
    v_mov_b32 v5, v9
k5_kernel_loop:
    s_waitcnt vmcnt(8)
    v_xor_b32 v4, 16384, v4
    ds_write_b128 v4, v[48:51] offset:0
    ds_write_b128 v4, v[52:55] offset:1024
    ds_write_b128 v4, v[56:59] offset:2048
    ds_write_b128 v4, v[60:63] offset:3072
    s_waitcnt lgkmcnt(0)
    buffer_load_dwordx4 v[48:51], v3, s[12:15], s34 offen offset:0
    buffer_load_dwordx4 v[52:55], v3, s[12:15], s34 offen offset:1024
    buffer_load_dwordx4 v[56:59], v3, s[12:15], s34 offen offset:2048
    buffer_load_dwordx4 v[60:63], v3, s[12:15], s34 offen offset:3072
    s_add_u32 s34, s34, 4096
    ds_read_b128 v[64:67], v5 offset:0
    ds_read_b128 v[68:71], v5 offset:4096
    ds_read_b128 v[72:75], v5 offset:8192
    ds_read_b128 v[76:79], v5 offset:12288
    s_waitcnt vmcnt(10)
    s_waitcnt lgkmcnt(3)
    v_mfma_f32_32x32x16_bf16 v[80:95], v[64:67], v[16:19], v[80:95]
    v_mfma_f32_32x32x16_bf16 v[144:159], v[64:67], v[20:23], v[144:159]
    s_waitcnt lgkmcnt(2)
    v_mfma_f32_32x32x16_bf16 v[96:111], v[68:71], v[16:19], v[96:111]
    v_mfma_f32_32x32x16_bf16 v[160:175], v[68:71], v[20:23], v[160:175]
    s_waitcnt lgkmcnt(1)
    v_mfma_f32_32x32x16_bf16 v[112:127], v[72:75], v[16:19], v[112:127]
    v_mfma_f32_32x32x16_bf16 v[176:191], v[72:75], v[20:23], v[176:191]
    s_waitcnt lgkmcnt(0)
    v_mfma_f32_32x32x16_bf16 v[128:143], v[76:79], v[16:19], v[128:143]
    v_mfma_f32_32x32x16_bf16 v[192:207], v[76:79], v[20:23], v[192:207]
    buffer_load_dwordx4 v[16:19], v1, s[8:11], s33 offen
    buffer_load_dwordx4 v[20:23], v2, s[8:11], s33 offen
    s_add_u32 s33, s33, 1024
    ds_read_b128 v[64:67], v5 offset:1024
    ds_read_b128 v[68:71], v5 offset:5120
    ds_read_b128 v[72:75], v5 offset:9216
    ds_read_b128 v[76:79], v5 offset:13312
    s_waitcnt vmcnt(10)
    s_waitcnt lgkmcnt(3)
    v_mfma_f32_32x32x16_bf16 v[80:95], v[64:67], v[24:27], v[80:95]
    v_mfma_f32_32x32x16_bf16 v[144:159], v[64:67], v[28:31], v[144:159]
    s_waitcnt lgkmcnt(2)
    v_mfma_f32_32x32x16_bf16 v[96:111], v[68:71], v[24:27], v[96:111]
    v_mfma_f32_32x32x16_bf16 v[160:175], v[68:71], v[28:31], v[160:175]
    s_waitcnt lgkmcnt(1)
    v_mfma_f32_32x32x16_bf16 v[112:127], v[72:75], v[24:27], v[112:127]
    v_mfma_f32_32x32x16_bf16 v[176:191], v[72:75], v[28:31], v[176:191]
    s_waitcnt lgkmcnt(0)
    v_mfma_f32_32x32x16_bf16 v[128:143], v[76:79], v[24:27], v[128:143]
    v_mfma_f32_32x32x16_bf16 v[192:207], v[76:79], v[28:31], v[192:207]
    buffer_load_dwordx4 v[24:27], v1, s[8:11], s33 offen
    buffer_load_dwordx4 v[28:31], v2, s[8:11], s33 offen
    s_add_u32 s33, s33, 1024
    ds_read_b128 v[64:67], v5 offset:2048
    ds_read_b128 v[68:71], v5 offset:6144
    ds_read_b128 v[72:75], v5 offset:10240
    ds_read_b128 v[76:79], v5 offset:14336
    s_waitcnt vmcnt(10)
    s_waitcnt lgkmcnt(3)
    v_mfma_f32_32x32x16_bf16 v[80:95], v[64:67], v[32:35], v[80:95]
    v_mfma_f32_32x32x16_bf16 v[144:159], v[64:67], v[36:39], v[144:159]
    s_waitcnt lgkmcnt(2)
    v_mfma_f32_32x32x16_bf16 v[96:111], v[68:71], v[32:35], v[96:111]
    v_mfma_f32_32x32x16_bf16 v[160:175], v[68:71], v[36:39], v[160:175]
    s_waitcnt lgkmcnt(1)
    v_mfma_f32_32x32x16_bf16 v[112:127], v[72:75], v[32:35], v[112:127]
    v_mfma_f32_32x32x16_bf16 v[176:191], v[72:75], v[36:39], v[176:191]
    s_waitcnt lgkmcnt(0)
    v_mfma_f32_32x32x16_bf16 v[128:143], v[76:79], v[32:35], v[128:143]
    v_mfma_f32_32x32x16_bf16 v[192:207], v[76:79], v[36:39], v[192:207]
    buffer_load_dwordx4 v[32:35], v1, s[8:11], s33 offen
    buffer_load_dwordx4 v[36:39], v2, s[8:11], s33 offen
    s_add_u32 s33, s33, 1024
    ds_read_b128 v[64:67], v5 offset:3072
    ds_read_b128 v[68:71], v5 offset:7168
    ds_read_b128 v[72:75], v5 offset:11264
    ds_read_b128 v[76:79], v5 offset:15360
    s_waitcnt vmcnt(10)
    s_waitcnt lgkmcnt(3)
    v_mfma_f32_32x32x16_bf16 v[80:95], v[64:67], v[40:43], v[80:95]
    v_mfma_f32_32x32x16_bf16 v[144:159], v[64:67], v[44:47], v[144:159]
    s_waitcnt lgkmcnt(2)
    v_mfma_f32_32x32x16_bf16 v[96:111], v[68:71], v[40:43], v[96:111]
    v_mfma_f32_32x32x16_bf16 v[160:175], v[68:71], v[44:47], v[160:175]
    s_waitcnt lgkmcnt(1)
    v_mfma_f32_32x32x16_bf16 v[112:127], v[72:75], v[40:43], v[112:127]
    v_mfma_f32_32x32x16_bf16 v[176:191], v[72:75], v[44:47], v[176:191]
    s_waitcnt lgkmcnt(0)
    v_mfma_f32_32x32x16_bf16 v[128:143], v[76:79], v[40:43], v[128:143]
    v_mfma_f32_32x32x16_bf16 v[192:207], v[76:79], v[44:47], v[192:207]
    buffer_load_dwordx4 v[40:43], v1, s[8:11], s33 offen
    buffer_load_dwordx4 v[44:47], v2, s[8:11], s33 offen
    s_add_u32 s33, s33, 1024
    v_xor_b32 v5, 16384, v5
    s_barrier
    s_add_u32 s36, s36, 1
    s_cmp_lt_u32 s36, 10
    s_cbranch_scc1 k5_kernel_loop
    s_nop 15
    v_and_b32 v10, 31, v0
    v_bfe_u32 v11, v0, 5, 1
    s_lshl_b32 s40, s24, 1
    s_add_u32 s40, s40, 0
    s_mul_i32 s40, s40, 111872
    s_lshl_b32 s41, s25, 12
    s_add_u32 s40, s40, s41
    s_add_u32 s40, s40, 0
    v_lshlrev_b32 v12, 4, v10
    v_lshl_add_u32 v12, v11, 3, v12
    v_cvt_pk_bf16_f32 v80, v80, v80
    v_lshlrev_b32 v80, 16, v80
    v_cvt_pk_bf16_f32 v96, v96, v96
    v_lshlrev_b32 v96, 16, v96
    v_mul_f32 v80, 0xbfb8aa3b, v80
    v_exp_f32 v80, v80
    s_nop 0
    v_add_f32 v80, 1.0, v80
    v_rcp_f32 v80, v80
    s_nop 0
    v_cvt_pk_bf16_f32 v80, v80, v80
    v_lshlrev_b32 v80, 16, v80
    v_mul_f32 v80, v80, v96
    v_cvt_pk_bf16_f32 v81, v81, v81
    v_lshlrev_b32 v81, 16, v81
    v_cvt_pk_bf16_f32 v97, v97, v97
    v_lshlrev_b32 v97, 16, v97
    v_mul_f32 v81, 0xbfb8aa3b, v81
    v_exp_f32 v81, v81
    s_nop 0
    v_add_f32 v81, 1.0, v81
    v_rcp_f32 v81, v81
    s_nop 0
    v_cvt_pk_bf16_f32 v81, v81, v81
    v_lshlrev_b32 v81, 16, v81
    v_mul_f32 v81, v81, v97
    v_cvt_pk_bf16_f32 v82, v82, v82
    v_lshlrev_b32 v82, 16, v82
    v_cvt_pk_bf16_f32 v98, v98, v98
    v_lshlrev_b32 v98, 16, v98
    v_mul_f32 v82, 0xbfb8aa3b, v82
    v_exp_f32 v82, v82
    s_nop 0
    v_add_f32 v82, 1.0, v82
    v_rcp_f32 v82, v82
    s_nop 0
    v_cvt_pk_bf16_f32 v82, v82, v82
    v_lshlrev_b32 v82, 16, v82
    v_mul_f32 v82, v82, v98
    v_cvt_pk_bf16_f32 v83, v83, v83
    v_lshlrev_b32 v83, 16, v83
    v_cvt_pk_bf16_f32 v99, v99, v99
    v_lshlrev_b32 v99, 16, v99
    v_mul_f32 v83, 0xbfb8aa3b, v83
    v_exp_f32 v83, v83
    s_nop 0
    v_add_f32 v83, 1.0, v83
    v_rcp_f32 v83, v83
    s_nop 0
    v_cvt_pk_bf16_f32 v83, v83, v83
    v_lshlrev_b32 v83, 16, v83
    v_mul_f32 v83, v83, v99
    v_cvt_pk_bf16_f32 v84, v84, v84
    v_lshlrev_b32 v84, 16, v84
    v_cvt_pk_bf16_f32 v100, v100, v100
    v_lshlrev_b32 v100, 16, v100
    v_mul_f32 v84, 0xbfb8aa3b, v84
    v_exp_f32 v84, v84
    s_nop 0
    v_add_f32 v84, 1.0, v84
    v_rcp_f32 v84, v84
    s_nop 0
    v_cvt_pk_bf16_f32 v84, v84, v84
    v_lshlrev_b32 v84, 16, v84
    v_mul_f32 v84, v84, v100
    v_cvt_pk_bf16_f32 v85, v85, v85
    v_lshlrev_b32 v85, 16, v85
    v_cvt_pk_bf16_f32 v101, v101, v101
    v_lshlrev_b32 v101, 16, v101
    v_mul_f32 v85, 0xbfb8aa3b, v85
    v_exp_f32 v85, v85
    s_nop 0
    v_add_f32 v85, 1.0, v85
    v_rcp_f32 v85, v85
    s_nop 0
    v_cvt_pk_bf16_f32 v85, v85, v85
    v_lshlrev_b32 v85, 16, v85
    v_mul_f32 v85, v85, v101
    v_cvt_pk_bf16_f32 v86, v86, v86
    v_lshlrev_b32 v86, 16, v86
    v_cvt_pk_bf16_f32 v102, v102, v102
    v_lshlrev_b32 v102, 16, v102
    v_mul_f32 v86, 0xbfb8aa3b, v86
    v_exp_f32 v86, v86
    s_nop 0
    v_add_f32 v86, 1.0, v86
    v_rcp_f32 v86, v86
    s_nop 0
    v_cvt_pk_bf16_f32 v86, v86, v86
    v_lshlrev_b32 v86, 16, v86
    v_mul_f32 v86, v86, v102
    v_cvt_pk_bf16_f32 v87, v87, v87
    v_lshlrev_b32 v87, 16, v87
    v_cvt_pk_bf16_f32 v103, v103, v103
    v_lshlrev_b32 v103, 16, v103
    v_mul_f32 v87, 0xbfb8aa3b, v87
    v_exp_f32 v87, v87
    s_nop 0
    v_add_f32 v87, 1.0, v87
    v_rcp_f32 v87, v87
    s_nop 0
    v_cvt_pk_bf16_f32 v87, v87, v87
    v_lshlrev_b32 v87, 16, v87
    v_mul_f32 v87, v87, v103
    v_cvt_pk_bf16_f32 v88, v88, v88
    v_lshlrev_b32 v88, 16, v88
    v_cvt_pk_bf16_f32 v104, v104, v104
    v_lshlrev_b32 v104, 16, v104
    v_mul_f32 v88, 0xbfb8aa3b, v88
    v_exp_f32 v88, v88
    s_nop 0
    v_add_f32 v88, 1.0, v88
    v_rcp_f32 v88, v88
    s_nop 0
    v_cvt_pk_bf16_f32 v88, v88, v88
    v_lshlrev_b32 v88, 16, v88
    v_mul_f32 v88, v88, v104
    v_cvt_pk_bf16_f32 v89, v89, v89
    v_lshlrev_b32 v89, 16, v89
    v_cvt_pk_bf16_f32 v105, v105, v105
    v_lshlrev_b32 v105, 16, v105
    v_mul_f32 v89, 0xbfb8aa3b, v89
    v_exp_f32 v89, v89
    s_nop 0
    v_add_f32 v89, 1.0, v89
    v_rcp_f32 v89, v89
    s_nop 0
    v_cvt_pk_bf16_f32 v89, v89, v89
    v_lshlrev_b32 v89, 16, v89
    v_mul_f32 v89, v89, v105
    v_cvt_pk_bf16_f32 v90, v90, v90
    v_lshlrev_b32 v90, 16, v90
    v_cvt_pk_bf16_f32 v106, v106, v106
    v_lshlrev_b32 v106, 16, v106
    v_mul_f32 v90, 0xbfb8aa3b, v90
    v_exp_f32 v90, v90
    s_nop 0
    v_add_f32 v90, 1.0, v90
    v_rcp_f32 v90, v90
    s_nop 0
    v_cvt_pk_bf16_f32 v90, v90, v90
    v_lshlrev_b32 v90, 16, v90
    v_mul_f32 v90, v90, v106
    v_cvt_pk_bf16_f32 v91, v91, v91
    v_lshlrev_b32 v91, 16, v91
    v_cvt_pk_bf16_f32 v107, v107, v107
    v_lshlrev_b32 v107, 16, v107
    v_mul_f32 v91, 0xbfb8aa3b, v91
    v_exp_f32 v91, v91
    s_nop 0
    v_add_f32 v91, 1.0, v91
    v_rcp_f32 v91, v91
    s_nop 0
    v_cvt_pk_bf16_f32 v91, v91, v91
    v_lshlrev_b32 v91, 16, v91
    v_mul_f32 v91, v91, v107
    v_cvt_pk_bf16_f32 v92, v92, v92
    v_lshlrev_b32 v92, 16, v92
    v_cvt_pk_bf16_f32 v108, v108, v108
    v_lshlrev_b32 v108, 16, v108
    v_mul_f32 v92, 0xbfb8aa3b, v92
    v_exp_f32 v92, v92
    s_nop 0
    v_add_f32 v92, 1.0, v92
    v_rcp_f32 v92, v92
    s_nop 0
    v_cvt_pk_bf16_f32 v92, v92, v92
    v_lshlrev_b32 v92, 16, v92
    v_mul_f32 v92, v92, v108
    v_cvt_pk_bf16_f32 v93, v93, v93
    v_lshlrev_b32 v93, 16, v93
    v_cvt_pk_bf16_f32 v109, v109, v109
    v_lshlrev_b32 v109, 16, v109
    v_mul_f32 v93, 0xbfb8aa3b, v93
    v_exp_f32 v93, v93
    s_nop 0
    v_add_f32 v93, 1.0, v93
    v_rcp_f32 v93, v93
    s_nop 0
    v_cvt_pk_bf16_f32 v93, v93, v93
    v_lshlrev_b32 v93, 16, v93
    v_mul_f32 v93, v93, v109
    v_cvt_pk_bf16_f32 v94, v94, v94
    v_lshlrev_b32 v94, 16, v94
    v_cvt_pk_bf16_f32 v110, v110, v110
    v_lshlrev_b32 v110, 16, v110
    v_mul_f32 v94, 0xbfb8aa3b, v94
    v_exp_f32 v94, v94
    s_nop 0
    v_add_f32 v94, 1.0, v94
    v_rcp_f32 v94, v94
    s_nop 0
    v_cvt_pk_bf16_f32 v94, v94, v94
    v_lshlrev_b32 v94, 16, v94
    v_mul_f32 v94, v94, v110
    v_cvt_pk_bf16_f32 v95, v95, v95
    v_lshlrev_b32 v95, 16, v95
    v_cvt_pk_bf16_f32 v111, v111, v111
    v_lshlrev_b32 v111, 16, v111
    v_mul_f32 v95, 0xbfb8aa3b, v95
    v_exp_f32 v95, v95
    s_nop 0
    v_add_f32 v95, 1.0, v95
    v_rcp_f32 v95, v95
    s_nop 0
    v_cvt_pk_bf16_f32 v95, v95, v95
    v_lshlrev_b32 v95, 16, v95
    v_mul_f32 v95, v95, v111
    v_cvt_pk_bf16_f32 v14, v80, v81
    v_cvt_pk_bf16_f32 v15, v82, v83
    buffer_store_dwordx2 v[14:15], v12, s[16:19], s40 offen offset:0
    s_nop 1
    v_cvt_pk_bf16_f32 v14, v84, v85
    v_cvt_pk_bf16_f32 v15, v86, v87
    buffer_store_dwordx2 v[14:15], v12, s[16:19], s40 offen offset:512
    s_nop 1
    v_cvt_pk_bf16_f32 v14, v88, v89
    v_cvt_pk_bf16_f32 v15, v90, v91
    buffer_store_dwordx2 v[14:15], v12, s[16:19], s40 offen offset:1024
    s_nop 1
    v_cvt_pk_bf16_f32 v14, v92, v93
    v_cvt_pk_bf16_f32 v15, v94, v95
    buffer_store_dwordx2 v[14:15], v12, s[16:19], s40 offen offset:1536
    s_nop 1
    s_lshl_b32 s40, s24, 1
    s_add_u32 s40, s40, 0
    s_mul_i32 s40, s40, 111872
    s_lshl_b32 s41, s25, 12
    s_add_u32 s40, s40, s41
    s_add_u32 s40, s40, 2048
    v_lshlrev_b32 v12, 4, v10
    v_lshl_add_u32 v12, v11, 3, v12
    v_cvt_pk_bf16_f32 v112, v112, v112
    v_lshlrev_b32 v112, 16, v112
    v_cvt_pk_bf16_f32 v128, v128, v128
    v_lshlrev_b32 v128, 16, v128
    v_mul_f32 v112, 0xbfb8aa3b, v112
    v_exp_f32 v112, v112
    s_nop 0
    v_add_f32 v112, 1.0, v112
    v_rcp_f32 v112, v112
    s_nop 0
    v_cvt_pk_bf16_f32 v112, v112, v112
    v_lshlrev_b32 v112, 16, v112
    v_mul_f32 v112, v112, v128
    v_cvt_pk_bf16_f32 v113, v113, v113
    v_lshlrev_b32 v113, 16, v113
    v_cvt_pk_bf16_f32 v129, v129, v129
    v_lshlrev_b32 v129, 16, v129
    v_mul_f32 v113, 0xbfb8aa3b, v113
    v_exp_f32 v113, v113
    s_nop 0
    v_add_f32 v113, 1.0, v113
    v_rcp_f32 v113, v113
    s_nop 0
    v_cvt_pk_bf16_f32 v113, v113, v113
    v_lshlrev_b32 v113, 16, v113
    v_mul_f32 v113, v113, v129
    v_cvt_pk_bf16_f32 v114, v114, v114
    v_lshlrev_b32 v114, 16, v114
    v_cvt_pk_bf16_f32 v130, v130, v130
    v_lshlrev_b32 v130, 16, v130
    v_mul_f32 v114, 0xbfb8aa3b, v114
    v_exp_f32 v114, v114
    s_nop 0
    v_add_f32 v114, 1.0, v114
    v_rcp_f32 v114, v114
    s_nop 0
    v_cvt_pk_bf16_f32 v114, v114, v114
    v_lshlrev_b32 v114, 16, v114
    v_mul_f32 v114, v114, v130
    v_cvt_pk_bf16_f32 v115, v115, v115
    v_lshlrev_b32 v115, 16, v115
    v_cvt_pk_bf16_f32 v131, v131, v131
    v_lshlrev_b32 v131, 16, v131
    v_mul_f32 v115, 0xbfb8aa3b, v115
    v_exp_f32 v115, v115
    s_nop 0
    v_add_f32 v115, 1.0, v115
    v_rcp_f32 v115, v115
    s_nop 0
    v_cvt_pk_bf16_f32 v115, v115, v115
    v_lshlrev_b32 v115, 16, v115
    v_mul_f32 v115, v115, v131
    v_cvt_pk_bf16_f32 v116, v116, v116
    v_lshlrev_b32 v116, 16, v116
    v_cvt_pk_bf16_f32 v132, v132, v132
    v_lshlrev_b32 v132, 16, v132
    v_mul_f32 v116, 0xbfb8aa3b, v116
    v_exp_f32 v116, v116
    s_nop 0
    v_add_f32 v116, 1.0, v116
    v_rcp_f32 v116, v116
    s_nop 0
    v_cvt_pk_bf16_f32 v116, v116, v116
    v_lshlrev_b32 v116, 16, v116
    v_mul_f32 v116, v116, v132
    v_cvt_pk_bf16_f32 v117, v117, v117
    v_lshlrev_b32 v117, 16, v117
    v_cvt_pk_bf16_f32 v133, v133, v133
    v_lshlrev_b32 v133, 16, v133
    v_mul_f32 v117, 0xbfb8aa3b, v117
    v_exp_f32 v117, v117
    s_nop 0
    v_add_f32 v117, 1.0, v117
    v_rcp_f32 v117, v117
    s_nop 0
    v_cvt_pk_bf16_f32 v117, v117, v117
    v_lshlrev_b32 v117, 16, v117
    v_mul_f32 v117, v117, v133
    v_cvt_pk_bf16_f32 v118, v118, v118
    v_lshlrev_b32 v118, 16, v118
    v_cvt_pk_bf16_f32 v134, v134, v134
    v_lshlrev_b32 v134, 16, v134
    v_mul_f32 v118, 0xbfb8aa3b, v118
    v_exp_f32 v118, v118
    s_nop 0
    v_add_f32 v118, 1.0, v118
    v_rcp_f32 v118, v118
    s_nop 0
    v_cvt_pk_bf16_f32 v118, v118, v118
    v_lshlrev_b32 v118, 16, v118
    v_mul_f32 v118, v118, v134
    v_cvt_pk_bf16_f32 v119, v119, v119
    v_lshlrev_b32 v119, 16, v119
    v_cvt_pk_bf16_f32 v135, v135, v135
    v_lshlrev_b32 v135, 16, v135
    v_mul_f32 v119, 0xbfb8aa3b, v119
    v_exp_f32 v119, v119
    s_nop 0
    v_add_f32 v119, 1.0, v119
    v_rcp_f32 v119, v119
    s_nop 0
    v_cvt_pk_bf16_f32 v119, v119, v119
    v_lshlrev_b32 v119, 16, v119
    v_mul_f32 v119, v119, v135
    v_cvt_pk_bf16_f32 v120, v120, v120
    v_lshlrev_b32 v120, 16, v120
    v_cvt_pk_bf16_f32 v136, v136, v136
    v_lshlrev_b32 v136, 16, v136
    v_mul_f32 v120, 0xbfb8aa3b, v120
    v_exp_f32 v120, v120
    s_nop 0
    v_add_f32 v120, 1.0, v120
    v_rcp_f32 v120, v120
    s_nop 0
    v_cvt_pk_bf16_f32 v120, v120, v120
    v_lshlrev_b32 v120, 16, v120
    v_mul_f32 v120, v120, v136
    v_cvt_pk_bf16_f32 v121, v121, v121
    v_lshlrev_b32 v121, 16, v121
    v_cvt_pk_bf16_f32 v137, v137, v137
    v_lshlrev_b32 v137, 16, v137
    v_mul_f32 v121, 0xbfb8aa3b, v121
    v_exp_f32 v121, v121
    s_nop 0
    v_add_f32 v121, 1.0, v121
    v_rcp_f32 v121, v121
    s_nop 0
    v_cvt_pk_bf16_f32 v121, v121, v121
    v_lshlrev_b32 v121, 16, v121
    v_mul_f32 v121, v121, v137
    v_cvt_pk_bf16_f32 v122, v122, v122
    v_lshlrev_b32 v122, 16, v122
    v_cvt_pk_bf16_f32 v138, v138, v138
    v_lshlrev_b32 v138, 16, v138
    v_mul_f32 v122, 0xbfb8aa3b, v122
    v_exp_f32 v122, v122
    s_nop 0
    v_add_f32 v122, 1.0, v122
    v_rcp_f32 v122, v122
    s_nop 0
    v_cvt_pk_bf16_f32 v122, v122, v122
    v_lshlrev_b32 v122, 16, v122
    v_mul_f32 v122, v122, v138
    v_cvt_pk_bf16_f32 v123, v123, v123
    v_lshlrev_b32 v123, 16, v123
    v_cvt_pk_bf16_f32 v139, v139, v139
    v_lshlrev_b32 v139, 16, v139
    v_mul_f32 v123, 0xbfb8aa3b, v123
    v_exp_f32 v123, v123
    s_nop 0
    v_add_f32 v123, 1.0, v123
    v_rcp_f32 v123, v123
    s_nop 0
    v_cvt_pk_bf16_f32 v123, v123, v123
    v_lshlrev_b32 v123, 16, v123
    v_mul_f32 v123, v123, v139
    v_cvt_pk_bf16_f32 v124, v124, v124
    v_lshlrev_b32 v124, 16, v124
    v_cvt_pk_bf16_f32 v140, v140, v140
    v_lshlrev_b32 v140, 16, v140
    v_mul_f32 v124, 0xbfb8aa3b, v124
    v_exp_f32 v124, v124
    s_nop 0
    v_add_f32 v124, 1.0, v124
    v_rcp_f32 v124, v124
    s_nop 0
    v_cvt_pk_bf16_f32 v124, v124, v124
    v_lshlrev_b32 v124, 16, v124
    v_mul_f32 v124, v124, v140
    v_cvt_pk_bf16_f32 v125, v125, v125
    v_lshlrev_b32 v125, 16, v125
    v_cvt_pk_bf16_f32 v141, v141, v141
    v_lshlrev_b32 v141, 16, v141
    v_mul_f32 v125, 0xbfb8aa3b, v125
    v_exp_f32 v125, v125
    s_nop 0
    v_add_f32 v125, 1.0, v125
    v_rcp_f32 v125, v125
    s_nop 0
    v_cvt_pk_bf16_f32 v125, v125, v125
    v_lshlrev_b32 v125, 16, v125
    v_mul_f32 v125, v125, v141
    v_cvt_pk_bf16_f32 v126, v126, v126
    v_lshlrev_b32 v126, 16, v126
    v_cvt_pk_bf16_f32 v142, v142, v142
    v_lshlrev_b32 v142, 16, v142
    v_mul_f32 v126, 0xbfb8aa3b, v126
    v_exp_f32 v126, v126
    s_nop 0
    v_add_f32 v126, 1.0, v126
    v_rcp_f32 v126, v126
    s_nop 0
    v_cvt_pk_bf16_f32 v126, v126, v126
    v_lshlrev_b32 v126, 16, v126
    v_mul_f32 v126, v126, v142
    v_cvt_pk_bf16_f32 v127, v127, v127
    v_lshlrev_b32 v127, 16, v127
    v_cvt_pk_bf16_f32 v143, v143, v143
    v_lshlrev_b32 v143, 16, v143
    v_mul_f32 v127, 0xbfb8aa3b, v127
    v_exp_f32 v127, v127
    s_nop 0
    v_add_f32 v127, 1.0, v127
    v_rcp_f32 v127, v127
    s_nop 0
    v_cvt_pk_bf16_f32 v127, v127, v127
    v_lshlrev_b32 v127, 16, v127
    v_mul_f32 v127, v127, v143
    v_cvt_pk_bf16_f32 v14, v112, v113
    v_cvt_pk_bf16_f32 v15, v114, v115
    buffer_store_dwordx2 v[14:15], v12, s[16:19], s40 offen offset:0
    s_nop 1
    v_cvt_pk_bf16_f32 v14, v116, v117
    v_cvt_pk_bf16_f32 v15, v118, v119
    buffer_store_dwordx2 v[14:15], v12, s[16:19], s40 offen offset:512
    s_nop 1
    v_cvt_pk_bf16_f32 v14, v120, v121
    v_cvt_pk_bf16_f32 v15, v122, v123
    buffer_store_dwordx2 v[14:15], v12, s[16:19], s40 offen offset:1024
    s_nop 1
    v_cvt_pk_bf16_f32 v14, v124, v125
    v_cvt_pk_bf16_f32 v15, v126, v127
    buffer_store_dwordx2 v[14:15], v12, s[16:19], s40 offen offset:1536
    s_nop 1
    s_lshl_b32 s40, s24, 1
    s_add_u32 s40, s40, 1
    s_mul_i32 s40, s40, 111872
    s_lshl_b32 s41, s25, 12
    s_add_u32 s40, s40, s41
    s_add_u32 s40, s40, 0
    v_lshlrev_b32 v12, 4, v10
    v_lshl_add_u32 v12, v11, 3, v12
    v_cvt_pk_bf16_f32 v144, v144, v144
    v_lshlrev_b32 v144, 16, v144
    v_cvt_pk_bf16_f32 v160, v160, v160
    v_lshlrev_b32 v160, 16, v160
    v_mul_f32 v144, 0xbfb8aa3b, v144
    v_exp_f32 v144, v144
    s_nop 0
    v_add_f32 v144, 1.0, v144
    v_rcp_f32 v144, v144
    s_nop 0
    v_cvt_pk_bf16_f32 v144, v144, v144
    v_lshlrev_b32 v144, 16, v144
    v_mul_f32 v144, v144, v160
    v_cvt_pk_bf16_f32 v145, v145, v145
    v_lshlrev_b32 v145, 16, v145
    v_cvt_pk_bf16_f32 v161, v161, v161
    v_lshlrev_b32 v161, 16, v161
    v_mul_f32 v145, 0xbfb8aa3b, v145
    v_exp_f32 v145, v145
    s_nop 0
    v_add_f32 v145, 1.0, v145
    v_rcp_f32 v145, v145
    s_nop 0
    v_cvt_pk_bf16_f32 v145, v145, v145
    v_lshlrev_b32 v145, 16, v145
    v_mul_f32 v145, v145, v161
    v_cvt_pk_bf16_f32 v146, v146, v146
    v_lshlrev_b32 v146, 16, v146
    v_cvt_pk_bf16_f32 v162, v162, v162
    v_lshlrev_b32 v162, 16, v162
    v_mul_f32 v146, 0xbfb8aa3b, v146
    v_exp_f32 v146, v146
    s_nop 0
    v_add_f32 v146, 1.0, v146
    v_rcp_f32 v146, v146
    s_nop 0
    v_cvt_pk_bf16_f32 v146, v146, v146
    v_lshlrev_b32 v146, 16, v146
    v_mul_f32 v146, v146, v162
    v_cvt_pk_bf16_f32 v147, v147, v147
    v_lshlrev_b32 v147, 16, v147
    v_cvt_pk_bf16_f32 v163, v163, v163
    v_lshlrev_b32 v163, 16, v163
    v_mul_f32 v147, 0xbfb8aa3b, v147
    v_exp_f32 v147, v147
    s_nop 0
    v_add_f32 v147, 1.0, v147
    v_rcp_f32 v147, v147
    s_nop 0
    v_cvt_pk_bf16_f32 v147, v147, v147
    v_lshlrev_b32 v147, 16, v147
    v_mul_f32 v147, v147, v163
    v_cvt_pk_bf16_f32 v148, v148, v148
    v_lshlrev_b32 v148, 16, v148
    v_cvt_pk_bf16_f32 v164, v164, v164
    v_lshlrev_b32 v164, 16, v164
    v_mul_f32 v148, 0xbfb8aa3b, v148
    v_exp_f32 v148, v148
    s_nop 0
    v_add_f32 v148, 1.0, v148
    v_rcp_f32 v148, v148
    s_nop 0
    v_cvt_pk_bf16_f32 v148, v148, v148
    v_lshlrev_b32 v148, 16, v148
    v_mul_f32 v148, v148, v164
    v_cvt_pk_bf16_f32 v149, v149, v149
    v_lshlrev_b32 v149, 16, v149
    v_cvt_pk_bf16_f32 v165, v165, v165
    v_lshlrev_b32 v165, 16, v165
    v_mul_f32 v149, 0xbfb8aa3b, v149
    v_exp_f32 v149, v149
    s_nop 0
    v_add_f32 v149, 1.0, v149
    v_rcp_f32 v149, v149
    s_nop 0
    v_cvt_pk_bf16_f32 v149, v149, v149
    v_lshlrev_b32 v149, 16, v149
    v_mul_f32 v149, v149, v165
    v_cvt_pk_bf16_f32 v150, v150, v150
    v_lshlrev_b32 v150, 16, v150
    v_cvt_pk_bf16_f32 v166, v166, v166
    v_lshlrev_b32 v166, 16, v166
    v_mul_f32 v150, 0xbfb8aa3b, v150
    v_exp_f32 v150, v150
    s_nop 0
    v_add_f32 v150, 1.0, v150
    v_rcp_f32 v150, v150
    s_nop 0
    v_cvt_pk_bf16_f32 v150, v150, v150
    v_lshlrev_b32 v150, 16, v150
    v_mul_f32 v150, v150, v166
    v_cvt_pk_bf16_f32 v151, v151, v151
    v_lshlrev_b32 v151, 16, v151
    v_cvt_pk_bf16_f32 v167, v167, v167
    v_lshlrev_b32 v167, 16, v167
    v_mul_f32 v151, 0xbfb8aa3b, v151
    v_exp_f32 v151, v151
    s_nop 0
    v_add_f32 v151, 1.0, v151
    v_rcp_f32 v151, v151
    s_nop 0
    v_cvt_pk_bf16_f32 v151, v151, v151
    v_lshlrev_b32 v151, 16, v151
    v_mul_f32 v151, v151, v167
    v_cvt_pk_bf16_f32 v152, v152, v152
    v_lshlrev_b32 v152, 16, v152
    v_cvt_pk_bf16_f32 v168, v168, v168
    v_lshlrev_b32 v168, 16, v168
    v_mul_f32 v152, 0xbfb8aa3b, v152
    v_exp_f32 v152, v152
    s_nop 0
    v_add_f32 v152, 1.0, v152
    v_rcp_f32 v152, v152
    s_nop 0
    v_cvt_pk_bf16_f32 v152, v152, v152
    v_lshlrev_b32 v152, 16, v152
    v_mul_f32 v152, v152, v168
    v_cvt_pk_bf16_f32 v153, v153, v153
    v_lshlrev_b32 v153, 16, v153
    v_cvt_pk_bf16_f32 v169, v169, v169
    v_lshlrev_b32 v169, 16, v169
    v_mul_f32 v153, 0xbfb8aa3b, v153
    v_exp_f32 v153, v153
    s_nop 0
    v_add_f32 v153, 1.0, v153
    v_rcp_f32 v153, v153
    s_nop 0
    v_cvt_pk_bf16_f32 v153, v153, v153
    v_lshlrev_b32 v153, 16, v153
    v_mul_f32 v153, v153, v169
    v_cvt_pk_bf16_f32 v154, v154, v154
    v_lshlrev_b32 v154, 16, v154
    v_cvt_pk_bf16_f32 v170, v170, v170
    v_lshlrev_b32 v170, 16, v170
    v_mul_f32 v154, 0xbfb8aa3b, v154
    v_exp_f32 v154, v154
    s_nop 0
    v_add_f32 v154, 1.0, v154
    v_rcp_f32 v154, v154
    s_nop 0
    v_cvt_pk_bf16_f32 v154, v154, v154
    v_lshlrev_b32 v154, 16, v154
    v_mul_f32 v154, v154, v170
    v_cvt_pk_bf16_f32 v155, v155, v155
    v_lshlrev_b32 v155, 16, v155
    v_cvt_pk_bf16_f32 v171, v171, v171
    v_lshlrev_b32 v171, 16, v171
    v_mul_f32 v155, 0xbfb8aa3b, v155
    v_exp_f32 v155, v155
    s_nop 0
    v_add_f32 v155, 1.0, v155
    v_rcp_f32 v155, v155
    s_nop 0
    v_cvt_pk_bf16_f32 v155, v155, v155
    v_lshlrev_b32 v155, 16, v155
    v_mul_f32 v155, v155, v171
    v_cvt_pk_bf16_f32 v156, v156, v156
    v_lshlrev_b32 v156, 16, v156
    v_cvt_pk_bf16_f32 v172, v172, v172
    v_lshlrev_b32 v172, 16, v172
    v_mul_f32 v156, 0xbfb8aa3b, v156
    v_exp_f32 v156, v156
    s_nop 0
    v_add_f32 v156, 1.0, v156
    v_rcp_f32 v156, v156
    s_nop 0
    v_cvt_pk_bf16_f32 v156, v156, v156
    v_lshlrev_b32 v156, 16, v156
    v_mul_f32 v156, v156, v172
    v_cvt_pk_bf16_f32 v157, v157, v157
    v_lshlrev_b32 v157, 16, v157
    v_cvt_pk_bf16_f32 v173, v173, v173
    v_lshlrev_b32 v173, 16, v173
    v_mul_f32 v157, 0xbfb8aa3b, v157
    v_exp_f32 v157, v157
    s_nop 0
    v_add_f32 v157, 1.0, v157
    v_rcp_f32 v157, v157
    s_nop 0
    v_cvt_pk_bf16_f32 v157, v157, v157
    v_lshlrev_b32 v157, 16, v157
    v_mul_f32 v157, v157, v173
    v_cvt_pk_bf16_f32 v158, v158, v158
    v_lshlrev_b32 v158, 16, v158
    v_cvt_pk_bf16_f32 v174, v174, v174
    v_lshlrev_b32 v174, 16, v174
    v_mul_f32 v158, 0xbfb8aa3b, v158
    v_exp_f32 v158, v158
    s_nop 0
    v_add_f32 v158, 1.0, v158
    v_rcp_f32 v158, v158
    s_nop 0
    v_cvt_pk_bf16_f32 v158, v158, v158
    v_lshlrev_b32 v158, 16, v158
    v_mul_f32 v158, v158, v174
    v_cvt_pk_bf16_f32 v159, v159, v159
    v_lshlrev_b32 v159, 16, v159
    v_cvt_pk_bf16_f32 v175, v175, v175
    v_lshlrev_b32 v175, 16, v175
    v_mul_f32 v159, 0xbfb8aa3b, v159
    v_exp_f32 v159, v159
    s_nop 0
    v_add_f32 v159, 1.0, v159
    v_rcp_f32 v159, v159
    s_nop 0
    v_cvt_pk_bf16_f32 v159, v159, v159
    v_lshlrev_b32 v159, 16, v159
    v_mul_f32 v159, v159, v175
    v_cvt_pk_bf16_f32 v14, v144, v145
    v_cvt_pk_bf16_f32 v15, v146, v147
    buffer_store_dwordx2 v[14:15], v12, s[16:19], s40 offen offset:0
    s_nop 1
    v_cvt_pk_bf16_f32 v14, v148, v149
    v_cvt_pk_bf16_f32 v15, v150, v151
    buffer_store_dwordx2 v[14:15], v12, s[16:19], s40 offen offset:512
    s_nop 1
    v_cvt_pk_bf16_f32 v14, v152, v153
    v_cvt_pk_bf16_f32 v15, v154, v155
    buffer_store_dwordx2 v[14:15], v12, s[16:19], s40 offen offset:1024
    s_nop 1
    v_cvt_pk_bf16_f32 v14, v156, v157
    v_cvt_pk_bf16_f32 v15, v158, v159
    buffer_store_dwordx2 v[14:15], v12, s[16:19], s40 offen offset:1536
    s_nop 1
    s_lshl_b32 s40, s24, 1
    s_add_u32 s40, s40, 1
    s_mul_i32 s40, s40, 111872
    s_lshl_b32 s41, s25, 12
    s_add_u32 s40, s40, s41
    s_add_u32 s40, s40, 2048
    v_lshlrev_b32 v12, 4, v10
    v_lshl_add_u32 v12, v11, 3, v12
    v_cvt_pk_bf16_f32 v176, v176, v176
    v_lshlrev_b32 v176, 16, v176
    v_cvt_pk_bf16_f32 v192, v192, v192
    v_lshlrev_b32 v192, 16, v192
    v_mul_f32 v176, 0xbfb8aa3b, v176
    v_exp_f32 v176, v176
    s_nop 0
    v_add_f32 v176, 1.0, v176
    v_rcp_f32 v176, v176
    s_nop 0
    v_cvt_pk_bf16_f32 v176, v176, v176
    v_lshlrev_b32 v176, 16, v176
    v_mul_f32 v176, v176, v192
    v_cvt_pk_bf16_f32 v177, v177, v177
    v_lshlrev_b32 v177, 16, v177
    v_cvt_pk_bf16_f32 v193, v193, v193
    v_lshlrev_b32 v193, 16, v193
    v_mul_f32 v177, 0xbfb8aa3b, v177
    v_exp_f32 v177, v177
    s_nop 0
    v_add_f32 v177, 1.0, v177
    v_rcp_f32 v177, v177
    s_nop 0
    v_cvt_pk_bf16_f32 v177, v177, v177
    v_lshlrev_b32 v177, 16, v177
    v_mul_f32 v177, v177, v193
    v_cvt_pk_bf16_f32 v178, v178, v178
    v_lshlrev_b32 v178, 16, v178
    v_cvt_pk_bf16_f32 v194, v194, v194
    v_lshlrev_b32 v194, 16, v194
    v_mul_f32 v178, 0xbfb8aa3b, v178
    v_exp_f32 v178, v178
    s_nop 0
    v_add_f32 v178, 1.0, v178
    v_rcp_f32 v178, v178
    s_nop 0
    v_cvt_pk_bf16_f32 v178, v178, v178
    v_lshlrev_b32 v178, 16, v178
    v_mul_f32 v178, v178, v194
    v_cvt_pk_bf16_f32 v179, v179, v179
    v_lshlrev_b32 v179, 16, v179
    v_cvt_pk_bf16_f32 v195, v195, v195
    v_lshlrev_b32 v195, 16, v195
    v_mul_f32 v179, 0xbfb8aa3b, v179
    v_exp_f32 v179, v179
    s_nop 0
    v_add_f32 v179, 1.0, v179
    v_rcp_f32 v179, v179
    s_nop 0
    v_cvt_pk_bf16_f32 v179, v179, v179
    v_lshlrev_b32 v179, 16, v179
    v_mul_f32 v179, v179, v195
    v_cvt_pk_bf16_f32 v180, v180, v180
    v_lshlrev_b32 v180, 16, v180
    v_cvt_pk_bf16_f32 v196, v196, v196
    v_lshlrev_b32 v196, 16, v196
    v_mul_f32 v180, 0xbfb8aa3b, v180
    v_exp_f32 v180, v180
    s_nop 0
    v_add_f32 v180, 1.0, v180
    v_rcp_f32 v180, v180
    s_nop 0
    v_cvt_pk_bf16_f32 v180, v180, v180
    v_lshlrev_b32 v180, 16, v180
    v_mul_f32 v180, v180, v196
    v_cvt_pk_bf16_f32 v181, v181, v181
    v_lshlrev_b32 v181, 16, v181
    v_cvt_pk_bf16_f32 v197, v197, v197
    v_lshlrev_b32 v197, 16, v197
    v_mul_f32 v181, 0xbfb8aa3b, v181
    v_exp_f32 v181, v181
    s_nop 0
    v_add_f32 v181, 1.0, v181
    v_rcp_f32 v181, v181
    s_nop 0
    v_cvt_pk_bf16_f32 v181, v181, v181
    v_lshlrev_b32 v181, 16, v181
    v_mul_f32 v181, v181, v197
    v_cvt_pk_bf16_f32 v182, v182, v182
    v_lshlrev_b32 v182, 16, v182
    v_cvt_pk_bf16_f32 v198, v198, v198
    v_lshlrev_b32 v198, 16, v198
    v_mul_f32 v182, 0xbfb8aa3b, v182
    v_exp_f32 v182, v182
    s_nop 0
    v_add_f32 v182, 1.0, v182
    v_rcp_f32 v182, v182
    s_nop 0
    v_cvt_pk_bf16_f32 v182, v182, v182
    v_lshlrev_b32 v182, 16, v182
    v_mul_f32 v182, v182, v198
    v_cvt_pk_bf16_f32 v183, v183, v183
    v_lshlrev_b32 v183, 16, v183
    v_cvt_pk_bf16_f32 v199, v199, v199
    v_lshlrev_b32 v199, 16, v199
    v_mul_f32 v183, 0xbfb8aa3b, v183
    v_exp_f32 v183, v183
    s_nop 0
    v_add_f32 v183, 1.0, v183
    v_rcp_f32 v183, v183
    s_nop 0
    v_cvt_pk_bf16_f32 v183, v183, v183
    v_lshlrev_b32 v183, 16, v183
    v_mul_f32 v183, v183, v199
    v_cvt_pk_bf16_f32 v184, v184, v184
    v_lshlrev_b32 v184, 16, v184
    v_cvt_pk_bf16_f32 v200, v200, v200
    v_lshlrev_b32 v200, 16, v200
    v_mul_f32 v184, 0xbfb8aa3b, v184
    v_exp_f32 v184, v184
    s_nop 0
    v_add_f32 v184, 1.0, v184
    v_rcp_f32 v184, v184
    s_nop 0
    v_cvt_pk_bf16_f32 v184, v184, v184
    v_lshlrev_b32 v184, 16, v184
    v_mul_f32 v184, v184, v200
    v_cvt_pk_bf16_f32 v185, v185, v185
    v_lshlrev_b32 v185, 16, v185
    v_cvt_pk_bf16_f32 v201, v201, v201
    v_lshlrev_b32 v201, 16, v201
    v_mul_f32 v185, 0xbfb8aa3b, v185
    v_exp_f32 v185, v185
    s_nop 0
    v_add_f32 v185, 1.0, v185
    v_rcp_f32 v185, v185
    s_nop 0
    v_cvt_pk_bf16_f32 v185, v185, v185
    v_lshlrev_b32 v185, 16, v185
    v_mul_f32 v185, v185, v201
    v_cvt_pk_bf16_f32 v186, v186, v186
    v_lshlrev_b32 v186, 16, v186
    v_cvt_pk_bf16_f32 v202, v202, v202
    v_lshlrev_b32 v202, 16, v202
    v_mul_f32 v186, 0xbfb8aa3b, v186
    v_exp_f32 v186, v186
    s_nop 0
    v_add_f32 v186, 1.0, v186
    v_rcp_f32 v186, v186
    s_nop 0
    v_cvt_pk_bf16_f32 v186, v186, v186
    v_lshlrev_b32 v186, 16, v186
    v_mul_f32 v186, v186, v202
    v_cvt_pk_bf16_f32 v187, v187, v187
    v_lshlrev_b32 v187, 16, v187
    v_cvt_pk_bf16_f32 v203, v203, v203
    v_lshlrev_b32 v203, 16, v203
    v_mul_f32 v187, 0xbfb8aa3b, v187
    v_exp_f32 v187, v187
    s_nop 0
    v_add_f32 v187, 1.0, v187
    v_rcp_f32 v187, v187
    s_nop 0
    v_cvt_pk_bf16_f32 v187, v187, v187
    v_lshlrev_b32 v187, 16, v187
    v_mul_f32 v187, v187, v203
    v_cvt_pk_bf16_f32 v188, v188, v188
    v_lshlrev_b32 v188, 16, v188
    v_cvt_pk_bf16_f32 v204, v204, v204
    v_lshlrev_b32 v204, 16, v204
    v_mul_f32 v188, 0xbfb8aa3b, v188
    v_exp_f32 v188, v188
    s_nop 0
    v_add_f32 v188, 1.0, v188
    v_rcp_f32 v188, v188
    s_nop 0
    v_cvt_pk_bf16_f32 v188, v188, v188
    v_lshlrev_b32 v188, 16, v188
    v_mul_f32 v188, v188, v204
    v_cvt_pk_bf16_f32 v189, v189, v189
    v_lshlrev_b32 v189, 16, v189
    v_cvt_pk_bf16_f32 v205, v205, v205
    v_lshlrev_b32 v205, 16, v205
    v_mul_f32 v189, 0xbfb8aa3b, v189
    v_exp_f32 v189, v189
    s_nop 0
    v_add_f32 v189, 1.0, v189
    v_rcp_f32 v189, v189
    s_nop 0
    v_cvt_pk_bf16_f32 v189, v189, v189
    v_lshlrev_b32 v189, 16, v189
    v_mul_f32 v189, v189, v205
    v_cvt_pk_bf16_f32 v190, v190, v190
    v_lshlrev_b32 v190, 16, v190
    v_cvt_pk_bf16_f32 v206, v206, v206
    v_lshlrev_b32 v206, 16, v206
    v_mul_f32 v190, 0xbfb8aa3b, v190
    v_exp_f32 v190, v190
    s_nop 0
    v_add_f32 v190, 1.0, v190
    v_rcp_f32 v190, v190
    s_nop 0
    v_cvt_pk_bf16_f32 v190, v190, v190
    v_lshlrev_b32 v190, 16, v190
    v_mul_f32 v190, v190, v206
    v_cvt_pk_bf16_f32 v191, v191, v191
    v_lshlrev_b32 v191, 16, v191
    v_cvt_pk_bf16_f32 v207, v207, v207
    v_lshlrev_b32 v207, 16, v207
    v_mul_f32 v191, 0xbfb8aa3b, v191
    v_exp_f32 v191, v191
    s_nop 0
    v_add_f32 v191, 1.0, v191
    v_rcp_f32 v191, v191
    s_nop 0
    v_cvt_pk_bf16_f32 v191, v191, v191
    v_lshlrev_b32 v191, 16, v191
    v_mul_f32 v191, v191, v207
    v_cvt_pk_bf16_f32 v14, v176, v177
    v_cvt_pk_bf16_f32 v15, v178, v179
    buffer_store_dwordx2 v[14:15], v12, s[16:19], s40 offen offset:0
    s_nop 1
    v_cvt_pk_bf16_f32 v14, v180, v181
    v_cvt_pk_bf16_f32 v15, v182, v183
    buffer_store_dwordx2 v[14:15], v12, s[16:19], s40 offen offset:512
    s_nop 1
    v_cvt_pk_bf16_f32 v14, v184, v185
    v_cvt_pk_bf16_f32 v15, v186, v187
    buffer_store_dwordx2 v[14:15], v12, s[16:19], s40 offen offset:1024
    s_nop 1
    v_cvt_pk_bf16_f32 v14, v188, v189
    v_cvt_pk_bf16_f32 v15, v190, v191
    buffer_store_dwordx2 v[14:15], v12, s[16:19], s40 offen offset:1536
    s_nop 1
k5_kernel_end:
    s_endpgm
.globl k6_kernel
.p2align 8
.type k6_kernel,@function
k6_kernel:
    s_cmp_ge_u32 s2, 320
    s_cbranch_scc1 k6_kernel_end
    s_load_dwordx2 s[4:5], s[0:1], 96
    s_load_dwordx2 s[6:7], s[0:1], 80
    s_lshr_b32 s3, s2, 3
    s_mul_hi_u32 s24, s3, 429496730
    s_mul_i32 s25, s24, 10
    s_sub_u32 s25, s3, s25
    s_and_b32 s3, s2, 7
    s_lshl_b32 s3, s3, 2
    s_add_u32 s24, s24, s3
    v_and_b32 v9, 63, v0
    v_lshlrev_b32 v9, 4, v9
    v_lshrrev_b32 v8, 6, v0
    s_nop 1
    v_readfirstlane_b32 s26, v8
    s_waitcnt lgkmcnt(0)
    s_add_u32 s8, s4, 23068672
    s_addc_u32 s9, s5, 0
    s_and_b32 s9, s9, 0xffff
    s_mov_b32 s10, 7159808
    s_mov_b32 s11, 0x00020000
    s_add_u32 s12, s4, 4718592
    s_addc_u32 s13, s5, 0
    s_and_b32 s13, s13, 0xffff
    s_mov_b32 s14, 2237440
    s_mov_b32 s15, 0x00020000
    s_add_u32 s16, s6, 0
    s_addc_u32 s17, s7, 0
    s_and_b32 s17, s17, 0xffff
    s_mov_b32 s18, 2621440
    s_mov_b32 s19, 0x00020000
    s_add_u32 s20, s4, 16777216
    s_addc_u32 s21, s5, 0
    s_and_b32 s21, s21, 0xffff
    s_mov_b32 s22, 2621440
    s_mov_b32 s23, 0x00020000
    s_lshl_b32 s27, s24, 1
    s_add_u32 s27, s27, 0
    s_mul_i32 s27, s27, 111872
    v_add_u32 v1, s27, v9
    s_lshl_b32 s27, s24, 1
    s_add_u32 s27, s27, 1
    s_mul_i32 s27, s27, 111872
    v_add_u32 v2, s27, v9
    s_mul_i32 s27, s25, 2
    s_add_u32 s27, s27, 0
    s_mul_i32 s27, s27, 111872
    v_add_u32 v3, s27, v9
    s_mul_i32 s27, s25, 2
    s_add_u32 s27, s27, 1
    s_mul_i32 s27, s27, 111872
    v_add_u32 v4, s27, v9
    v_mov_b32 v64, 0
    v_mov_b32 v65, 0
    v_mov_b32 v66, 0
    v_mov_b32 v67, 0
    v_mov_b32 v68, 0
    v_mov_b32 v69, 0
    v_mov_b32 v70, 0
    v_mov_b32 v71, 0
    v_mov_b32 v72, 0
    v_mov_b32 v73, 0
    v_mov_b32 v74, 0
    v_mov_b32 v75, 0
    v_mov_b32 v76, 0
    v_mov_b32 v77, 0
    v_mov_b32 v78, 0
    v_mov_b32 v79, 0
    v_mov_b32 v80, 0
    v_mov_b32 v81, 0
    v_mov_b32 v82, 0
    v_mov_b32 v83, 0
    v_mov_b32 v84, 0
    v_mov_b32 v85, 0
    v_mov_b32 v86, 0
    v_mov_b32 v87, 0
    v_mov_b32 v88, 0
    v_mov_b32 v89, 0
    v_mov_b32 v90, 0
    v_mov_b32 v91, 0
    v_mov_b32 v92, 0
    v_mov_b32 v93, 0
    v_mov_b32 v94, 0
    v_mov_b32 v95, 0
    v_mov_b32 v96, 0
    v_mov_b32 v97, 0
    v_mov_b32 v98, 0
    v_mov_b32 v99, 0
    v_mov_b32 v100, 0
    v_mov_b32 v101, 0
    v_mov_b32 v102, 0
    v_mov_b32 v103, 0
    v_mov_b32 v104, 0
    v_mov_b32 v105, 0
    v_mov_b32 v106, 0
    v_mov_b32 v107, 0
    v_mov_b32 v108, 0
    v_mov_b32 v109, 0
    v_mov_b32 v110, 0
    v_mov_b32 v111, 0
    v_mov_b32 v112, 0
    v_mov_b32 v113, 0
    v_mov_b32 v114, 0
    v_mov_b32 v115, 0
    v_mov_b32 v116, 0
    v_mov_b32 v117, 0
    v_mov_b32 v118, 0
    v_mov_b32 v119, 0
    v_mov_b32 v120, 0
    v_mov_b32 v121, 0
    v_mov_b32 v122, 0
    v_mov_b32 v123, 0
    v_mov_b32 v124, 0
    v_mov_b32 v125, 0
    v_mov_b32 v126, 0
    v_mov_b32 v127, 0
    s_mul_i32 s33, s26, 27648
    buffer_load_dwordx4 v[16:19], v1, s[8:11], s33 offen
    buffer_load_dwordx4 v[20:23], v2, s[8:11], s33 offen
    buffer_load_dwordx4 v[24:27], v3, s[12:15], s33 offen
    buffer_load_dwordx4 v[28:31], v4, s[12:15], s33 offen
    s_add_u32 s33, s33, 1024
    buffer_load_dwordx4 v[32:35], v1, s[8:11], s33 offen
    buffer_load_dwordx4 v[36:39], v2, s[8:11], s33 offen
    buffer_load_dwordx4 v[40:43], v3, s[12:15], s33 offen
    buffer_load_dwordx4 v[44:47], v4, s[12:15], s33 offen
    s_add_u32 s33, s33, 1024
    buffer_load_dwordx4 v[48:51], v1, s[8:11], s33 offen
    buffer_load_dwordx4 v[52:55], v2, s[8:11], s33 offen
    buffer_load_dwordx4 v[56:59], v3, s[12:15], s33 offen
    buffer_load_dwordx4 v[60:63], v4, s[12:15], s33 offen
    s_add_u32 s33, s33, 1024
    s_mov_b32 s36, 0
k6_kernel_loop:
    s_waitcnt vmcnt(8)
    v_mfma_f32_32x32x16_bf16 v[64:79], v[24:27], v[16:19], v[64:79]
    v_mfma_f32_32x32x16_bf16 v[80:95], v[28:31], v[16:19], v[80:95]
    v_mfma_f32_32x32x16_bf16 v[96:111], v[24:27], v[20:23], v[96:111]
    v_mfma_f32_32x32x16_bf16 v[112:127], v[28:31], v[20:23], v[112:127]
    buffer_load_dwordx4 v[16:19], v1, s[8:11], s33 offen
    buffer_load_dwordx4 v[20:23], v2, s[8:11], s33 offen
    buffer_load_dwordx4 v[24:27], v3, s[12:15], s33 offen
    buffer_load_dwordx4 v[28:31], v4, s[12:15], s33 offen
    s_add_u32 s33, s33, 1024
    s_waitcnt vmcnt(8)
    v_mfma_f32_32x32x16_bf16 v[64:79], v[40:43], v[32:35], v[64:79]
    v_mfma_f32_32x32x16_bf16 v[80:95], v[44:47], v[32:35], v[80:95]
    v_mfma_f32_32x32x16_bf16 v[96:111], v[40:43], v[36:39], v[96:111]
    v_mfma_f32_32x32x16_bf16 v[112:127], v[44:47], v[36:39], v[112:127]
    buffer_load_dwordx4 v[32:35], v1, s[8:11], s33 offen
    buffer_load_dwordx4 v[36:39], v2, s[8:11], s33 offen
    buffer_load_dwordx4 v[40:43], v3, s[12:15], s33 offen
    buffer_load_dwordx4 v[44:47], v4, s[12:15], s33 offen
    s_add_u32 s33, s33, 1024
    s_waitcnt vmcnt(8)
    v_mfma_f32_32x32x16_bf16 v[64:79], v[56:59], v[48:51], v[64:79]
    v_mfma_f32_32x32x16_bf16 v[80:95], v[60:63], v[48:51], v[80:95]
    v_mfma_f32_32x32x16_bf16 v[96:111], v[56:59], v[52:55], v[96:111]
    v_mfma_f32_32x32x16_bf16 v[112:127], v[60:63], v[52:55], v[112:127]
    buffer_load_dwordx4 v[48:51], v1, s[8:11], s33 offen
    buffer_load_dwordx4 v[52:55], v2, s[8:11], s33 offen
    buffer_load_dwordx4 v[56:59], v3, s[12:15], s33 offen
    buffer_load_dwordx4 v[60:63], v4, s[12:15], s33 offen
    s_add_u32 s33, s33, 1024
    s_add_u32 s36, s36, 1
    s_cmp_lt_u32 s36, 9
    s_cbranch_scc1 k6_kernel_loop
    s_nop 15
    v_and_b32 v10, 31, v0
    v_bfe_u32 v11, v0, 5, 1
    s_waitcnt vmcnt(0)
    s_lshl_b32 s40, s26, 14
    v_add_u32 v8, s40, v9
    ds_write_b128 v8, v[64:67] offset:0
    ds_write_b128 v8, v[68:71] offset:1024
    ds_write_b128 v8, v[72:75] offset:2048
    ds_write_b128 v8, v[76:79] offset:3072
    ds_write_b128 v8, v[80:83] offset:4096
    ds_write_b128 v8, v[84:87] offset:5120
    ds_write_b128 v8, v[88:91] offset:6144
    ds_write_b128 v8, v[92:95] offset:7168
    ds_write_b128 v8, v[96:99] offset:8192
    ds_write_b128 v8, v[100:103] offset:9216
    ds_write_b128 v8, v[104:107] offset:10240
    ds_write_b128 v8, v[108:111] offset:11264
    ds_write_b128 v8, v[112:115] offset:12288
    ds_write_b128 v8, v[116:119] offset:13312
    ds_write_b128 v8, v[120:123] offset:14336
    ds_write_b128 v8, v[124:127] offset:15360
    s_lshr_b32 s30, s26, 1
    s_and_b32 s31, s26, 1
    s_lshl_b32 s40, s24, 6
    s_lshl_b32 s41, s30, 5
    s_add_u32 s40, s40, s41
    v_add_u32 v12, s40, v10
    v_mul_u32_u24 v12, 1280, v12
    s_lshl_b32 s40, s25, 7
    s_lshl_b32 s41, s31, 6
    s_add_u32 s40, s40, s41
    v_lshl_add_u32 v13, v11, 3, s40
    v_add_u32 v12, v12, v13
    buffer_load_dwordx2 v[16:17], v12, s[20:23], 0 offen offset:0
    buffer_load_dwordx2 v[18:19], v12, s[20:23], 0 offen offset:16
    buffer_load_dwordx2 v[20:21], v12, s[20:23], 0 offen offset:32
    buffer_load_dwordx2 v[22:23], v12, s[20:23], 0 offen offset:48
    s_lshl_b32 s40, s26, 12
    v_add_u32 v8, s40, v9
    s_waitcnt lgkmcnt(0)
    s_barrier
    ds_read_b128 v[64:67], v8 offset:0
    ds_read_b128 v[68:71], v8 offset:1024
    ds_read_b128 v[72:75], v8 offset:2048
    ds_read_b128 v[76:79], v8 offset:3072
    ds_read_b128 v[80:83], v8 offset:16384
    ds_read_b128 v[84:87], v8 offset:17408
    ds_read_b128 v[88:91], v8 offset:18432
    ds_read_b128 v[92:95], v8 offset:19456
    ds_read_b128 v[96:99], v8 offset:32768
    ds_read_b128 v[100:103], v8 offset:33792
    ds_read_b128 v[104:107], v8 offset:34816
    ds_read_b128 v[108:111], v8 offset:35840
    ds_read_b128 v[112:115], v8 offset:49152
    ds_read_b128 v[116:119], v8 offset:50176
    ds_read_b128 v[120:123], v8 offset:51200
    ds_read_b128 v[124:127], v8 offset:52224
    s_waitcnt lgkmcnt(0) vmcnt(0)
    v_add_f32 v64, v64, v80
    v_add_f32 v96, v96, v112
    v_add_f32 v64, v64, v96
    v_add_f32 v65, v65, v81
    v_add_f32 v97, v97, v113
    v_add_f32 v65, v65, v97
    v_add_f32 v66, v66, v82
    v_add_f32 v98, v98, v114
    v_add_f32 v66, v66, v98
    v_add_f32 v67, v67, v83
    v_add_f32 v99, v99, v115
    v_add_f32 v67, v67, v99
    v_add_f32 v68, v68, v84
    v_add_f32 v100, v100, v116
    v_add_f32 v68, v68, v100
    v_add_f32 v69, v69, v85
    v_add_f32 v101, v101, v117
    v_add_f32 v69, v69, v101
    v_add_f32 v70, v70, v86
    v_add_f32 v102, v102, v118
    v_add_f32 v70, v70, v102
    v_add_f32 v71, v71, v87
    v_add_f32 v103, v103, v119
    v_add_f32 v71, v71, v103
    v_add_f32 v72, v72, v88
    v_add_f32 v104, v104, v120
    v_add_f32 v72, v72, v104
    v_add_f32 v73, v73, v89
    v_add_f32 v105, v105, v121
    v_add_f32 v73, v73, v105
    v_add_f32 v74, v74, v90
    v_add_f32 v106, v106, v122
    v_add_f32 v74, v74, v106
    v_add_f32 v75, v75, v91
    v_add_f32 v107, v107, v123
    v_add_f32 v75, v75, v107
    v_add_f32 v76, v76, v92
    v_add_f32 v108, v108, v124
    v_add_f32 v76, v76, v108
    v_add_f32 v77, v77, v93
    v_add_f32 v109, v109, v125
    v_add_f32 v77, v77, v109
    v_add_f32 v78, v78, v94
    v_add_f32 v110, v110, v126
    v_add_f32 v78, v78, v110
    v_add_f32 v79, v79, v95
    v_add_f32 v111, v111, v127
    v_add_f32 v79, v79, v111
    v_cvt_pk_bf16_f32 v64, v64, v64
    v_lshlrev_b32 v64, 16, v64
    v_lshlrev_b32 v14, 16, v16
    v_add_f32 v64, v64, v14
    v_cvt_pk_bf16_f32 v65, v65, v65
    v_lshlrev_b32 v65, 16, v65
    v_and_b32 v14, 0xffff0000, v16
    v_add_f32 v65, v65, v14
    v_cvt_pk_bf16_f32 v66, v66, v66
    v_lshlrev_b32 v66, 16, v66
    v_lshlrev_b32 v14, 16, v17
    v_add_f32 v66, v66, v14
    v_cvt_pk_bf16_f32 v67, v67, v67
    v_lshlrev_b32 v67, 16, v67
    v_and_b32 v14, 0xffff0000, v17
    v_add_f32 v67, v67, v14
    v_cvt_pk_bf16_f32 v24, v64, v65
    v_cvt_pk_bf16_f32 v25, v66, v67
    v_cvt_pk_bf16_f32 v68, v68, v68
    v_lshlrev_b32 v68, 16, v68
    v_lshlrev_b32 v14, 16, v18
    v_add_f32 v68, v68, v14
    v_cvt_pk_bf16_f32 v69, v69, v69
    v_lshlrev_b32 v69, 16, v69
    v_and_b32 v14, 0xffff0000, v18
    v_add_f32 v69, v69, v14
    v_cvt_pk_bf16_f32 v70, v70, v70
    v_lshlrev_b32 v70, 16, v70
    v_lshlrev_b32 v14, 16, v19
    v_add_f32 v70, v70, v14
    v_cvt_pk_bf16_f32 v71, v71, v71
    v_lshlrev_b32 v71, 16, v71
    v_and_b32 v14, 0xffff0000, v19
    v_add_f32 v71, v71, v14
    v_cvt_pk_bf16_f32 v26, v68, v69
    v_cvt_pk_bf16_f32 v27, v70, v71
    v_cvt_pk_bf16_f32 v72, v72, v72
    v_lshlrev_b32 v72, 16, v72
    v_lshlrev_b32 v14, 16, v20
    v_add_f32 v72, v72, v14
    v_cvt_pk_bf16_f32 v73, v73, v73
    v_lshlrev_b32 v73, 16, v73
    v_and_b32 v14, 0xffff0000, v20
    v_add_f32 v73, v73, v14
    v_cvt_pk_bf16_f32 v74, v74, v74
    v_lshlrev_b32 v74, 16, v74
    v_lshlrev_b32 v14, 16, v21
    v_add_f32 v74, v74, v14
    v_cvt_pk_bf16_f32 v75, v75, v75
    v_lshlrev_b32 v75, 16, v75
    v_and_b32 v14, 0xffff0000, v21
    v_add_f32 v75, v75, v14
    v_cvt_pk_bf16_f32 v28, v72, v73
    v_cvt_pk_bf16_f32 v29, v74, v75
    v_cvt_pk_bf16_f32 v76, v76, v76
    v_lshlrev_b32 v76, 16, v76
    v_lshlrev_b32 v14, 16, v22
    v_add_f32 v76, v76, v14
    v_cvt_pk_bf16_f32 v77, v77, v77
    v_lshlrev_b32 v77, 16, v77
    v_and_b32 v14, 0xffff0000, v22
    v_add_f32 v77, v77, v14
    v_cvt_pk_bf16_f32 v78, v78, v78
    v_lshlrev_b32 v78, 16, v78
    v_lshlrev_b32 v14, 16, v23
    v_add_f32 v78, v78, v14
    v_cvt_pk_bf16_f32 v79, v79, v79
    v_lshlrev_b32 v79, 16, v79
    v_and_b32 v14, 0xffff0000, v23
    v_add_f32 v79, v79, v14
    v_cvt_pk_bf16_f32 v30, v76, v77
    v_cvt_pk_bf16_f32 v31, v78, v79
    buffer_store_dwordx2 v[24:25], v12, s[16:19], 0 offen offset:0
    buffer_store_dwordx2 v[26:27], v12, s[16:19], 0 offen offset:16
    buffer_store_dwordx2 v[28:29], v12, s[16:19], 0 offen offset:32
    buffer_store_dwordx2 v[30:31], v12, s[16:19], 0 offen offset:48
k6_kernel_end:
    s_endpgm
.section .rodata,"a"
.p2align 6
.amdhsa_kernel ka_kernel
  .amdhsa_next_free_vgpr 80
  .amdhsa_next_free_sgpr 102
  .amdhsa_accum_offset 80
  .amdhsa_group_segment_fixed_size 0
  .amdhsa_kernarg_size 104
  .amdhsa_user_sgpr_count 2
  .amdhsa_user_sgpr_kernarg_segment_ptr 1
  .amdhsa_system_sgpr_workgroup_id_x 1
.end_amdhsa_kernel
.p2align 6
.amdhsa_kernel k0_kernel
  .amdhsa_next_free_vgpr 160
  .amdhsa_next_free_sgpr 102
  .amdhsa_accum_offset 160
  .amdhsa_group_segment_fixed_size 0
  .amdhsa_kernarg_size 104
  .amdhsa_user_sgpr_count 2
  .amdhsa_user_sgpr_kernarg_segment_ptr 1
  .amdhsa_system_sgpr_workgroup_id_x 1
.end_amdhsa_kernel
.p2align 6
.amdhsa_kernel k1_kernel
  .amdhsa_next_free_vgpr 184
  .amdhsa_next_free_sgpr 102
  .amdhsa_accum_offset 184
  .amdhsa_group_segment_fixed_size 0
  .amdhsa_kernarg_size 104
  .amdhsa_user_sgpr_count 2
  .amdhsa_user_sgpr_kernarg_segment_ptr 1
  .amdhsa_system_sgpr_workgroup_id_x 1
.end_amdhsa_kernel
.p2align 6
.amdhsa_kernel k2_kernel
  .amdhsa_next_free_vgpr 208
  .amdhsa_next_free_sgpr 102
  .amdhsa_accum_offset 208
  .amdhsa_group_segment_fixed_size 0
  .amdhsa_kernarg_size 104
  .amdhsa_user_sgpr_count 2
  .amdhsa_user_sgpr_kernarg_segment_ptr 1
  .amdhsa_system_sgpr_workgroup_id_x 1
.end_amdhsa_kernel
.p2align 6
.amdhsa_kernel k3_kernel
  .amdhsa_next_free_vgpr 128
  .amdhsa_next_free_sgpr 102
  .amdhsa_accum_offset 128
  .amdhsa_group_segment_fixed_size 0
  .amdhsa_kernarg_size 104
  .amdhsa_user_sgpr_count 2
  .amdhsa_user_sgpr_kernarg_segment_ptr 1
  .amdhsa_system_sgpr_workgroup_id_x 1
.end_amdhsa_kernel
.p2align 6
.amdhsa_kernel k4_kernel
  .amdhsa_next_free_vgpr 184
  .amdhsa_next_free_sgpr 102
  .amdhsa_accum_offset 184
  .amdhsa_group_segment_fixed_size 0
  .amdhsa_kernarg_size 104
  .amdhsa_user_sgpr_count 2
  .amdhsa_user_sgpr_kernarg_segment_ptr 1
  .amdhsa_system_sgpr_workgroup_id_x 1
.end_amdhsa_kernel
.p2align 6
.amdhsa_kernel k5_kernel
  .amdhsa_next_free_vgpr 208
  .amdhsa_next_free_sgpr 102
  .amdhsa_accum_offset 208
  .amdhsa_group_segment_fixed_size 0
  .amdhsa_kernarg_size 104
  .amdhsa_user_sgpr_count 2
  .amdhsa_user_sgpr_kernarg_segment_ptr 1
  .amdhsa_system_sgpr_workgroup_id_x 1
.end_amdhsa_kernel
.p2align 6
.amdhsa_kernel k6_kernel
  .amdhsa_next_free_vgpr 128
  .amdhsa_next_free_sgpr 102
  .amdhsa_accum_offset 128
  .amdhsa_group_segment_fixed_size 0
  .amdhsa_kernarg_size 104
  .amdhsa_user_sgpr_count 2
  .amdhsa_user_sgpr_kernarg_segment_ptr 1
  .amdhsa_system_sgpr_workgroup_id_x 1
.end_amdhsa_kernel
```
